```python
import torch

def _softmax(x, axis=-1):
    return torch.softmax(x, dim=axis)
def _gelu(x):
    return torch.nn.functional.gelu(x, approximate="tanh")
def _silu(x):
    return torch.nn.functional.silu(x)
def _sigmoid(x):
    return torch.sigmoid(x)
def _layernorm(x, axis=-1, eps=1e-5):
    m = x.mean(dim=axis, keepdim=True)
    v = x.var(dim=axis, keepdim=True, unbiased=False)
    return (x - m) / torch.sqrt(v + eps)
def _scatter_add(tgt, idx, src, axis=0):
    return tgt.clone().index_add_(axis, idx, src)
def _segment_sum(src, seg, n):
    out = torch.zeros((n,) + src.shape[1:], dtype=src.dtype)
    return out.index_add_(0, seg, src)
def _pad(x, pw):
    flat = tuple(v for pair in reversed(pw) for v in pair)
    return torch.nn.functional.pad(x, flat)

kernel_name = 'parallel_sum__sliding_block_cached__geglu_ffn__decode'

def setup_inputs():

    _w = (lambda a: (lambda t: t.to(torch.bfloat16) if t.is_floating_point() else t)(torch.as_tensor(a)))
    def _A_setup():
        B, Sq, D = 2, 1, 448
        Hq, Hkv, Sk, Dh = 16, 8, 32768, 256
        assert Hq % Hkv == 0, (Hq, Hkv)
        return {
            "x": _w((lambda *s: torch.randn(*s, dtype=torch.bfloat16) * 0.05)(B, Sq, D)),
            "k_cache": _w((lambda *s: torch.randn(*s, dtype=torch.bfloat16) * 3.2)(B, Hkv, Sk, Dh)),
            "v_cache": _w((lambda *s: torch.randn(*s, dtype=torch.bfloat16) * 1.6)(B, Hkv, Sk, Dh)),
            "wq": _w((lambda *s: torch.randn(*s, dtype=torch.bfloat16) * 3.2)(D, Hq * Dh) * (D ** -0.5)),
            "wo": _w((lambda *s: torch.randn(*s, dtype=torch.bfloat16) * 1.6)(Hq * Dh, D) * ((Hq * Dh) ** -0.5)),
        }
    _A_in = _A_setup()

    def _B_setup():
        B, S, D, F = 2, 1, 448, 1792
        return {
            "x": _w((lambda *s: torch.randn(*s, dtype=torch.bfloat16) * 0.05)(B, S, D)),
            "w_gate": _w((lambda *s: torch.randn(*s, dtype=torch.bfloat16) * 0.05)(D, F)),
            "w_up": _w((lambda *s: torch.randn(*s, dtype=torch.bfloat16) * 0.05)(D, F)),
            "w_down": _w((lambda *s: torch.randn(*s, dtype=torch.bfloat16) * 0.05)(F, D)),
        }
    _B_in = _B_setup()

    return {
        "A_x": _A_in["x"],
        "A_k_cache": _A_in["k_cache"],
        "A_v_cache": _A_in["v_cache"],
        "A_wq": _A_in["wq"],
        "A_wo": _A_in["wo"],
        "B_x": _B_in["x"],
        "B_w_gate": _B_in["w_gate"],
        "B_w_up": _B_in["w_up"],
        "B_w_down": _B_in["w_down"],
    }

def reference(A_x, A_k_cache, A_v_cache, A_wq, A_wo, B_x, B_w_gate, B_w_up, B_w_down):
    def _A_ref(x, k_cache, v_cache, wq, wo):
        B, Sq, D = x.shape
        Hq, Dh = 16, 256
        Hkv, Sk = k_cache.shape[1], k_cache.shape[2]
        W = min(4096, max(256, Sk // 4))
        rep = Hq // Hkv
        q = (lambda x, *d: x.permute(*d))((x @ wq).reshape(B, Sq, Hq, Dh), 0, 2, 1, 3)
        k = (lambda x, n, axis: torch.repeat_interleave(x, n, dim=axis))(k_cache[:, :, Sk - W:, :], rep, axis=1)
        v = (lambda x, n, axis: torch.repeat_interleave(x, n, dim=axis))(v_cache[:, :, Sk - W:, :], rep, axis=1)
        scores = torch.einsum("bhqd,bhkd->bhqk", q, k) * (Dh ** -0.5)
        p = _softmax(scores, axis=-1)
        o = torch.einsum("bhqk,bhkd->bhqd", p, v)
        return (lambda x, *d: x.permute(*d))(o, 0, 2, 1, 3).reshape(B, Sq, Hq * Dh) @ wo

    def _B_ref(x, w_gate, w_up, w_down):
        return (_gelu(x @ w_gate) * (x @ w_up)) @ w_down

    x = A_x
    xn = _layernorm(x, axis=-1)
    return x + _A_ref(xn, A_k_cache, A_v_cache, A_wq, A_wo) + _B_ref(xn, B_w_gate, B_w_up, B_w_down)
```

```asm
; @launch grid=(256,1,1) block=(512,1,1) lds=26624
.amdgcn_target "amdgcn-amd-amdhsa--gfx950"
.text
.globl parallel_sum__sliding_block_cached__geglu_ffn__decode_kernel
.p2align 8
.type parallel_sum__sliding_block_cached__geglu_ffn__decode_kernel,@function
parallel_sum__sliding_block_cached__geglu_ffn__decode_kernel:
    s_cmp_ge_u32 s2, 256
    s_cbranch_scc1 L_end
    s_load_dwordx16 s[4:19], s[0:1], 0
    s_load_dwordx8 s[20:27], s[0:1], 64
    v_lshrrev_b32 v2, 6, v0
    v_and_b32 v1, 63, v0
    s_and_b32 s29, s2, 7
    v_readfirstlane_b32 s28, v2
    s_lshr_b32 s30, s2, 3
    s_lshr_b32 s31, s30, 4
    s_and_b32 s32, s30, 15
    s_cmp_ge_u32 s28, 4
    s_cbranch_scc1 L_streamer
    s_setprio 2
    v_mov_b32 v3, 5120
    v_mov_b32 v4, 0
    v_lshl_add_u32 v8, v1, 2, v3
    ds_write_b32 v8, v4
    v_and_b32 v5, 31, v1
    v_lshrrev_b32 v6, 5, v1
    v_mul_u32_u24 v7, 896, v6
    v_lshl_add_u32 v7, v5, 5, v7
    v_cmp_gt_u32 s[70:71], 28, v5
    v_mov_b32 v8, 0x10000
    s_lshl_b32 s34, s32, 3
    s_add_u32 s34, s34, s29
    s_cmp_ge_u32 s34, 56
    s_cselect_b32 s35, 56, 0
    s_cselect_b32 s67, 2, 0
    s_sub_u32 s35, s34, s35
    s_cmp_ge_u32 s35, 28
    s_cselect_b32 s72, 28, 0
    s_cselect_b32 s66, 1, 0
    s_sub_u32 s35, s35, s72
    s_add_u32 s67, s67, s66
    s_lshl_b32 s72, s29, 3
    s_and_b32 s73, s32, 7
    s_add_u32 s72, s72, s73
    s_lshr_b32 s73, s32, 3
    v_cndmask_b32 v7, v8, v7, s[70:71]
    s_cmp_eq_u32 s31, 0
    s_cselect_b32 s35, s72, s35
    s_cselect_b32 s66, s73, s66
    s_mov_b32 s72, 3584
    s_cselect_b32 s72, 8192, s72
    s_mul_i32 s73, s66, 224
    s_mul_i32 s74, s28, 56
    s_add_u32 s65, s73, s74
    v_lshrrev_b32 v9, 3, v1
    v_add_u32 v9, s65, v9
    v_and_b32 v10, 7, v1
    v_lshlrev_b32 v10, 4, v10
    v_mad_u32_u24 v9, v9, s72, v10
    s_lshl_b32 s73, s35, 7
    v_add_u32 v9, s73, v9
    s_lshl_b32 s73, s72, 3
    s_mov_b32 s52, 0
    s_mul_i32 s53, s73, 1
    s_mul_i32 s54, s73, 2
    s_mul_i32 s55, s73, 3
    s_mul_i32 s56, s73, 4
    s_mul_i32 s57, s73, 5
    s_mul_i32 s58, s73, 6
    s_cmp_lt_u32 s34, 112
    s_cselect_b32 s74, 1605632, 0
    s_cmp_eq_u32 s31, 0
    s_cselect_b32 s42, 3670016, s74
    s_mov_b32 s43, 0x20000
    s_mov_b32 s38, 1792
    s_mov_b32 s39, 0x20000
    s_getpc_b64 s[74:75]
L_pc:
    s_sub_u32 s74, s74, L_pc-parallel_sum__sliding_block_cached__geglu_ffn__decode_kernel
    s_subb_u32 s75, s75, 0
    v_lshl_add_u32 v11, s30, 3, v1
    v_lshlrev_b32 v11, 6, v11
    v_min_u32 v11, L_end-parallel_sum__sliding_block_cached__geglu_ffn__decode_kernel, v11
    s_waitcnt lgkmcnt(0)
    s_mov_b32 s36, s4
    s_mov_b32 s37, s5
    buffer_load_dwordx4 v[12:15], v7, s[36:39], 0 offen
    buffer_load_dwordx4 v[16:19], v7, s[36:39], 0 offen offset:16
    s_load_dword s33, s[26:27], 0
    s_cmp_ge_u32 s34, 56
    s_cselect_b32 s40, s18, s16
    s_cselect_b32 s41, s19, s17
    s_cmp_eq_u32 s31, 0
    s_cselect_b32 s40, s10, s40
    s_cselect_b32 s41, s11, s41
    s_mov_b64 exec, 0xff
    global_load_dword v100, v11, s[74:75]
    s_mov_b64 exec, -1
    buffer_load_dwordx4 v[64:67], v9, s[40:43], s52 offen nt
    buffer_load_dwordx4 v[68:71], v9, s[40:43], s53 offen nt
    buffer_load_dwordx4 v[72:75], v9, s[40:43], s54 offen nt
    buffer_load_dwordx4 v[76:79], v9, s[40:43], s55 offen nt
    buffer_load_dwordx4 v[80:83], v9, s[40:43], s56 offen nt
    buffer_load_dwordx4 v[84:87], v9, s[40:43], s57 offen nt
    buffer_load_dwordx4 v[88:91], v9, s[40:43], s58 offen nt
    s_barrier
    s_branch L_helper2
L_streamer:
    s_mul_i32 s34, s2, 0x9E3779B1
    s_lshr_b32 s34, s34, 26
    s_sub_u32 s28, s28, 4
    s_lshr_b32 s35, s34, 4
    s_and_b32 s35, s35, 3
    s_xor_b32 s35, s35, s28
    s_lshl_b32 s35, s35, 15
    s_and_b32 s34, s34, 15
    s_lshl_b32 s34, s34, 11
    s_lshl_b32 s72, s31, 3
    s_add_u32 s72, s72, s29
    s_lshl_b32 s72, s72, 24
    s_lshl_b32 s73, s32, 17
    s_add_u32 s72, s72, s73
    s_add_u32 s72, s72, s35
    s_add_u32 s72, s72, 14680064
    v_bfe_u32 v2, v1, 2, 2
    v_lshlrev_b32 v2, 9, v2
    v_lshrrev_b32 v4, 4, v1
    v_lshl_add_u32 v2, v4, 6, v2
    v_and_b32 v5, 3, v1
    v_lshl_add_u32 v2, v5, 4, v2
    s_mov_b32 s38, 32768
    s_mov_b32 s39, 0x20000
    s_mov_b32 s42, 32768
    s_mov_b32 s43, 0x20000
    s_xor_b32 s52, s34, 0
    s_xor_b32 s53, s34, 2048
    s_xor_b32 s54, s34, 4096
    s_xor_b32 s55, s34, 6144
    s_xor_b32 s56, s34, 8192
    s_xor_b32 s57, s34, 10240
    s_xor_b32 s58, s34, 12288
    s_xor_b32 s59, s34, 14336
    s_xor_b32 s60, s34, 16384
    s_xor_b32 s61, s34, 18432
    s_xor_b32 s62, s34, 20480
    s_xor_b32 s63, s34, 22528
    s_xor_b32 s64, s34, 24576
    s_xor_b32 s65, s34, 26624
    s_xor_b32 s66, s34, 28672
    s_xor_b32 s67, s34, 30720
    s_waitcnt lgkmcnt(0)
    s_add_u32 s36, s6, s72
    s_addc_u32 s37, s7, 0
    s_add_u32 s40, s8, s72
    s_addc_u32 s41, s9, 0
    buffer_load_dwordx4 v[64:67], v2, s[36:39], s52 offen offset:0 nt
    buffer_load_dwordx4 v[68:71], v2, s[36:39], s52 offen offset:256 nt
    s_barrier
    v_and_b32 v6, 15, v1
    v_lshlrev_b32 v3, 9, v4
    v_lshl_add_u32 v3, v6, 4, v3
    v_mov_b32 v7, 5132
    v_mov_b32 v8, 1
    buffer_load_dwordx4 v[72:75], v2, s[36:39], s53 offen offset:0 nt
    buffer_load_dwordx4 v[76:79], v2, s[36:39], s53 offen offset:256 nt
    buffer_load_dwordx4 v[80:83], v2, s[36:39], s54 offen offset:0 nt
    buffer_load_dwordx4 v[84:87], v2, s[36:39], s54 offen offset:256 nt
    buffer_load_dwordx4 v[88:91], v2, s[36:39], s55 offen offset:0 nt
    buffer_load_dwordx4 v[92:95], v2, s[36:39], s55 offen offset:256 nt
    buffer_load_dwordx4 v[96:99], v2, s[36:39], s56 offen offset:0 nt
    buffer_load_dwordx4 v[100:103], v2, s[36:39], s56 offen offset:256 nt
    s_waitcnt vmcnt(9)
    buffer_load_dwordx4 v[104:107], v2, s[36:39], s57 offen offset:0 nt
    s_waitcnt vmcnt(9)
    buffer_load_dwordx4 v[108:111], v2, s[36:39], s57 offen offset:256 nt
    s_waitcnt vmcnt(9)
    buffer_load_dwordx4 v[112:115], v2, s[36:39], s58 offen offset:0 nt
    s_waitcnt vmcnt(9)
    buffer_load_dwordx4 v[116:119], v2, s[36:39], s58 offen offset:256 nt
    s_waitcnt vmcnt(9)
    buffer_load_dwordx4 v[120:123], v2, s[36:39], s59 offen offset:0 nt
    s_waitcnt vmcnt(9)
    buffer_load_dwordx4 v[124:127], v2, s[36:39], s59 offen offset:256 nt
    s_waitcnt vmcnt(9)
    buffer_load_dwordx4 v[128:131], v2, s[36:39], s60 offen offset:0 nt
    s_waitcnt vmcnt(9)
    buffer_load_dwordx4 v[132:135], v2, s[36:39], s60 offen offset:256 nt
    s_waitcnt vmcnt(9)
    buffer_load_dwordx4 v[136:139], v2, s[36:39], s61 offen offset:0 nt
    s_waitcnt vmcnt(9)
    buffer_load_dwordx4 v[140:143], v2, s[36:39], s61 offen offset:256 nt
    s_waitcnt vmcnt(9)
    buffer_load_dwordx4 v[144:147], v2, s[36:39], s62 offen offset:0 nt
    s_waitcnt vmcnt(9)
    buffer_load_dwordx4 v[148:151], v2, s[36:39], s62 offen offset:256 nt
    s_waitcnt vmcnt(9)
    buffer_load_dwordx4 v[152:155], v2, s[36:39], s63 offen offset:0 nt
    s_waitcnt vmcnt(9)
    buffer_load_dwordx4 v[156:159], v2, s[36:39], s63 offen offset:256 nt
    s_waitcnt vmcnt(9)
    buffer_load_dwordx4 v[160:163], v2, s[36:39], s64 offen offset:0 nt
    s_waitcnt vmcnt(9)
    buffer_load_dwordx4 v[164:167], v2, s[36:39], s64 offen offset:256 nt
    s_waitcnt vmcnt(9)
    buffer_load_dwordx4 v[168:171], v2, s[36:39], s65 offen offset:0 nt
    s_waitcnt vmcnt(9)
    buffer_load_dwordx4 v[172:175], v2, s[36:39], s65 offen offset:256 nt
    s_waitcnt vmcnt(9)
    buffer_load_dwordx4 v[176:179], v2, s[36:39], s66 offen offset:0 nt
    s_waitcnt vmcnt(9)
    buffer_load_dwordx4 v[180:183], v2, s[36:39], s66 offen offset:256 nt
    s_waitcnt vmcnt(9)
    buffer_load_dwordx4 v[184:187], v2, s[36:39], s67 offen offset:0 nt
    s_waitcnt vmcnt(9)
    buffer_load_dwordx4 v[188:191], v2, s[36:39], s67 offen offset:256 nt
    ds_write_b32 v7, v8
    s_waitcnt vmcnt(9)
    buffer_load_dwordx4 v[192:195], v3, s[40:43], s52 offen offset:0 nt
    s_waitcnt vmcnt(9)
    buffer_load_dwordx4 v[196:199], v3, s[40:43], s52 offen offset:256 nt
    s_waitcnt vmcnt(9)
    buffer_load_dwordx4 v[200:203], v3, s[40:43], s53 offen offset:0 nt
    s_waitcnt vmcnt(9)
    buffer_load_dwordx4 v[204:207], v3, s[40:43], s53 offen offset:256 nt
    s_waitcnt vmcnt(9)
    buffer_load_dwordx4 v[208:211], v3, s[40:43], s54 offen offset:0 nt
    s_waitcnt vmcnt(9)
    buffer_load_dwordx4 v[212:215], v3, s[40:43], s54 offen offset:256 nt
    s_waitcnt vmcnt(9)
    buffer_load_dwordx4 v[216:219], v3, s[40:43], s55 offen offset:0 nt
    s_waitcnt vmcnt(9)
    buffer_load_dwordx4 v[220:223], v3, s[40:43], s55 offen offset:256 nt
    buffer_load_dwordx4 v[224:227], v3, s[40:43], s56 offen offset:0 nt
    buffer_load_dwordx4 v[228:231], v3, s[40:43], s56 offen offset:256 nt
    s_waitcnt vmcnt(11)
    buffer_load_dwordx4 v[232:235], v3, s[40:43], s57 offen offset:0 nt
    s_waitcnt vmcnt(11)
    buffer_load_dwordx4 v[236:239], v3, s[40:43], s57 offen offset:256 nt
    s_branch L_streamer2
L_helper2:
    s_waitcnt vmcnt(8)
    v_lshlrev_b32 v20, 16, v12
    v_and_b32 v21, 0xffff0000, v12
    v_lshlrev_b32 v22, 16, v13
    v_and_b32 v23, 0xffff0000, v13
    v_lshlrev_b32 v24, 16, v14
    v_and_b32 v25, 0xffff0000, v14
    v_lshlrev_b32 v26, 16, v15
    v_and_b32 v27, 0xffff0000, v15
    v_lshlrev_b32 v28, 16, v16
    v_and_b32 v29, 0xffff0000, v16
    v_lshlrev_b32 v30, 16, v17
    v_and_b32 v31, 0xffff0000, v17
    v_lshlrev_b32 v32, 16, v18
    v_and_b32 v33, 0xffff0000, v18
    v_lshlrev_b32 v34, 16, v19
    v_and_b32 v35, 0xffff0000, v19
    v_pk_add_f32 v[36:37], v[20:21], v[22:23]
    v_pk_add_f32 v[38:39], v[24:25], v[26:27]
    v_pk_add_f32 v[40:41], v[28:29], v[30:31]
    v_pk_add_f32 v[42:43], v[32:33], v[34:35]
    v_pk_add_f32 v[36:37], v[36:37], v[38:39]
    v_pk_add_f32 v[40:41], v[40:41], v[42:43]
    v_pk_add_f32 v[36:37], v[36:37], v[40:41]
    v_add_f32 v36, v36, v37
    s_mov_b32 s72, 0x3b124925
    s_mov_b32 s73, 0x43e00000
    v_add_f32_dpp v36, v36, v36 quad_perm:[1,0,3,2] row_mask:0xf bank_mask:0xf
    s_nop 1
    v_add_f32_dpp v36, v36, v36 quad_perm:[2,3,0,1] row_mask:0xf bank_mask:0xf
    s_nop 1
    v_add_f32_dpp v36, v36, v36 row_half_mirror row_mask:0xf bank_mask:0xf
    s_nop 1
    v_add_f32_dpp v36, v36, v36 row_mirror row_mask:0xf bank_mask:0xf
    v_mov_b32 v37, v36
    s_nop 1
    v_permlane16_swap_b32 v37, v36
    v_add_f32 v36, v36, v37
    v_mul_f32 v38, s72, v36
    v_fma_f32 v39, -v38, s73, v36
    v_fma_f32 v36, v39, s72, v38
    v_cndmask_b32 v38, 0, v36, s[70:71]
    v_pk_add_f32 v[40:41], v[20:21], v[38:39] op_sel_hi:[1,0] neg_lo:[0,1] neg_hi:[0,1]
    v_pk_add_f32 v[42:43], v[22:23], v[38:39] op_sel_hi:[1,0] neg_lo:[0,1] neg_hi:[0,1]
    v_pk_add_f32 v[44:45], v[24:25], v[38:39] op_sel_hi:[1,0] neg_lo:[0,1] neg_hi:[0,1]
    v_pk_add_f32 v[46:47], v[26:27], v[38:39] op_sel_hi:[1,0] neg_lo:[0,1] neg_hi:[0,1]
    v_pk_add_f32 v[48:49], v[28:29], v[38:39] op_sel_hi:[1,0] neg_lo:[0,1] neg_hi:[0,1]
    v_pk_add_f32 v[50:51], v[30:31], v[38:39] op_sel_hi:[1,0] neg_lo:[0,1] neg_hi:[0,1]
    v_pk_add_f32 v[52:53], v[32:33], v[38:39] op_sel_hi:[1,0] neg_lo:[0,1] neg_hi:[0,1]
    v_pk_add_f32 v[54:55], v[34:35], v[38:39] op_sel_hi:[1,0] neg_lo:[0,1] neg_hi:[0,1]
    v_pk_mul_f32 v[56:57], v[40:41], v[40:41]
    v_pk_mul_f32 v[58:59], v[42:43], v[42:43]
    v_pk_fma_f32 v[56:57], v[44:45], v[44:45], v[56:57]
    v_pk_fma_f32 v[58:59], v[46:47], v[46:47], v[58:59]
    v_pk_fma_f32 v[56:57], v[48:49], v[48:49], v[56:57]
    v_pk_fma_f32 v[58:59], v[50:51], v[50:51], v[58:59]
    v_pk_fma_f32 v[56:57], v[52:53], v[52:53], v[56:57]
    v_pk_fma_f32 v[58:59], v[54:55], v[54:55], v[58:59]
    v_pk_add_f32 v[56:57], v[56:57], v[58:59]
    v_add_f32 v56, v56, v57
    v_cvt_pk_bf16_f32 v36, v36, v36
    v_lshlrev_b32 v36, 16, v36
    v_add_f32_dpp v56, v56, v56 quad_perm:[1,0,3,2] row_mask:0xf bank_mask:0xf
    s_nop 1
    v_add_f32_dpp v56, v56, v56 quad_perm:[2,3,0,1] row_mask:0xf bank_mask:0xf
    s_nop 1
    v_add_f32_dpp v56, v56, v56 row_half_mirror row_mask:0xf bank_mask:0xf
    s_nop 1
    v_add_f32_dpp v56, v56, v56 row_mirror row_mask:0xf bank_mask:0xf
    v_mov_b32 v57, v56
    s_nop 1
    v_permlane16_swap_b32 v57, v56
    v_add_f32 v56, v56, v57
    v_mul_f32 v58, s72, v56
    v_fma_f32 v59, -v58, s73, v56
    v_fma_f32 v56, v59, s72, v58
    v_cvt_pk_bf16_f32 v56, v56, v56
    v_lshlrev_b32 v56, 16, v56
    v_add_f32 v56, 0x3727c5ac, v56
    v_cvt_pk_bf16_f32 v56, v56, v56
    v_lshlrev_b32 v56, 16, v56
    v_sqrt_f32 v56, v56
    s_nop 0
    v_cvt_pk_bf16_f32 v56, v56, v56
    v_lshlrev_b32 v56, 16, v56
    v_rcp_f32 v56, v56
    v_pk_add_f32 v[40:41], v[20:21], v[36:37] op_sel_hi:[1,0] neg_lo:[0,1] neg_hi:[0,1]
    v_pk_add_f32 v[42:43], v[22:23], v[36:37] op_sel_hi:[1,0] neg_lo:[0,1] neg_hi:[0,1]
    v_pk_add_f32 v[44:45], v[24:25], v[36:37] op_sel_hi:[1,0] neg_lo:[0,1] neg_hi:[0,1]
    v_pk_add_f32 v[46:47], v[26:27], v[36:37] op_sel_hi:[1,0] neg_lo:[0,1] neg_hi:[0,1]
    v_pk_add_f32 v[48:49], v[28:29], v[36:37] op_sel_hi:[1,0] neg_lo:[0,1] neg_hi:[0,1]
    v_pk_add_f32 v[50:51], v[30:31], v[36:37] op_sel_hi:[1,0] neg_lo:[0,1] neg_hi:[0,1]
    v_pk_add_f32 v[52:53], v[32:33], v[36:37] op_sel_hi:[1,0] neg_lo:[0,1] neg_hi:[0,1]
    v_pk_add_f32 v[54:55], v[34:35], v[36:37] op_sel_hi:[1,0] neg_lo:[0,1] neg_hi:[0,1]
    v_cvt_pk_bf16_f32 v12, v40, v41
    v_cvt_pk_bf16_f32 v13, v42, v43
    v_cvt_pk_bf16_f32 v14, v44, v45
    v_cvt_pk_bf16_f32 v15, v46, v47
    v_cvt_pk_bf16_f32 v16, v48, v49
    v_cvt_pk_bf16_f32 v17, v50, v51
    v_cvt_pk_bf16_f32 v18, v52, v53
    v_cvt_pk_bf16_f32 v19, v54, v55
    v_lshlrev_b32 v40, 16, v12
    v_and_b32 v41, 0xffff0000, v12
    v_lshlrev_b32 v42, 16, v13
    v_and_b32 v43, 0xffff0000, v13
    v_lshlrev_b32 v44, 16, v14
    v_and_b32 v45, 0xffff0000, v14
    v_lshlrev_b32 v46, 16, v15
    v_and_b32 v47, 0xffff0000, v15
    v_lshlrev_b32 v48, 16, v16
    v_and_b32 v49, 0xffff0000, v16
    v_lshlrev_b32 v50, 16, v17
    v_and_b32 v51, 0xffff0000, v17
    v_lshlrev_b32 v52, 16, v18
    v_and_b32 v53, 0xffff0000, v18
    v_lshlrev_b32 v54, 16, v19
    v_and_b32 v55, 0xffff0000, v19
    v_pk_mul_f32 v[40:41], v[40:41], v[56:57] op_sel_hi:[1,0]
    v_pk_mul_f32 v[42:43], v[42:43], v[56:57] op_sel_hi:[1,0]
    v_pk_mul_f32 v[44:45], v[44:45], v[56:57] op_sel_hi:[1,0]
    v_pk_mul_f32 v[46:47], v[46:47], v[56:57] op_sel_hi:[1,0]
    v_pk_mul_f32 v[48:49], v[48:49], v[56:57] op_sel_hi:[1,0]
    v_pk_mul_f32 v[50:51], v[50:51], v[56:57] op_sel_hi:[1,0]
    v_pk_mul_f32 v[52:53], v[52:53], v[56:57] op_sel_hi:[1,0]
    v_pk_mul_f32 v[54:55], v[54:55], v[56:57] op_sel_hi:[1,0]
    v_cvt_pk_bf16_f32 v12, v40, v41
    v_cvt_pk_bf16_f32 v13, v42, v43
    v_cvt_pk_bf16_f32 v14, v44, v45
    v_cvt_pk_bf16_f32 v15, v46, v47
    v_cvt_pk_bf16_f32 v16, v48, v49
    v_cvt_pk_bf16_f32 v17, v50, v51
    v_cvt_pk_bf16_f32 v18, v52, v53
    v_cvt_pk_bf16_f32 v19, v54, v55
    v_lshlrev_b32 v40, 16, v12
    v_and_b32 v41, 0xffff0000, v12
    v_lshlrev_b32 v42, 16, v13
    v_and_b32 v43, 0xffff0000, v13
    v_lshlrev_b32 v44, 16, v14
    v_and_b32 v45, 0xffff0000, v14
    v_lshlrev_b32 v46, 16, v15
    v_and_b32 v47, 0xffff0000, v15
    v_lshlrev_b32 v48, 16, v16
    v_and_b32 v49, 0xffff0000, v16
    v_lshlrev_b32 v50, 16, v17
    v_and_b32 v51, 0xffff0000, v17
    v_lshlrev_b32 v52, 16, v18
    v_and_b32 v53, 0xffff0000, v18
    v_lshlrev_b32 v54, 16, v19
    v_and_b32 v55, 0xffff0000, v19
    v_mul_u32_u24 v7, 1792, v6
    v_lshl_add_u32 v7, v5, 6, v7
    s_lshl_b32 s72, s65, 2
    v_lshrrev_b32 v8, 3, v1
    v_lshl_add_u32 v8, v8, 2, s72
    s_mov_b64 exec, s[70:71]
    ds_write_b128 v7, v[40:43] offset:0
    ds_write_b128 v7, v[44:47] offset:16
    ds_write_b128 v7, v[48:51] offset:32
    ds_write_b128 v7, v[52:55] offset:48
    s_mov_b64 exec, -1
    v_add_u32 v10, 1792, v8
    s_waitcnt lgkmcnt(0)
    s_mul_i32 s33, s33, 0x41C64E6D
    s_add_u32 s33, s33, 0x3C6EF35F
    s_mov_b32 s98, s33
    s_mov_b32 s99, s33
    ds_read2_b32 v[20:21], v8 offset0:0 offset1:8
    ds_read2_b32 v[22:23], v8 offset0:16 offset1:24
    ds_read2_b32 v[24:25], v8 offset0:32 offset1:40
    ds_read_b32 v26, v8 offset:192
    ds_read2_b32 v[28:29], v10 offset0:0 offset1:8
    ds_read2_b32 v[30:31], v10 offset0:16 offset1:24
    ds_read2_b32 v[32:33], v10 offset0:32 offset1:40
    ds_read_b32 v34, v10 offset:192
    s_getreg_b32 s64, hwreg(HW_REG_XCC_ID, 0, 4)
    s_waitcnt lgkmcnt(0)
    s_waitcnt vmcnt(6)
    v_lshlrev_b32 v56, 16, v64
    v_and_b32 v57, 0xffff0000, v64
    v_lshlrev_b32 v58, 16, v65
    v_and_b32 v59, 0xffff0000, v65
    v_lshlrev_b32 v60, 16, v66
    v_and_b32 v61, 0xffff0000, v66
    v_lshlrev_b32 v62, 16, v67
    v_and_b32 v63, 0xffff0000, v67
    v_pk_mul_f32 v[40:41], v[56:57], v[20:21] op_sel:[0,0] op_sel_hi:[1,0]
    v_pk_mul_f32 v[42:43], v[58:59], v[20:21] op_sel:[0,0] op_sel_hi:[1,0]
    v_pk_mul_f32 v[44:45], v[60:61], v[20:21] op_sel:[0,0] op_sel_hi:[1,0]
    v_pk_mul_f32 v[46:47], v[62:63], v[20:21] op_sel:[0,0] op_sel_hi:[1,0]
    v_pk_mul_f32 v[48:49], v[56:57], v[28:29] op_sel:[0,0] op_sel_hi:[1,0]
    v_pk_mul_f32 v[50:51], v[58:59], v[28:29] op_sel:[0,0] op_sel_hi:[1,0]
    v_pk_mul_f32 v[52:53], v[60:61], v[28:29] op_sel:[0,0] op_sel_hi:[1,0]
    v_pk_mul_f32 v[54:55], v[62:63], v[28:29] op_sel:[0,0] op_sel_hi:[1,0]
    s_waitcnt vmcnt(5)
    v_lshlrev_b32 v56, 16, v68
    v_and_b32 v57, 0xffff0000, v68
    v_lshlrev_b32 v58, 16, v69
    v_and_b32 v59, 0xffff0000, v69
    v_lshlrev_b32 v60, 16, v70
    v_and_b32 v61, 0xffff0000, v70
    v_lshlrev_b32 v62, 16, v71
    v_and_b32 v63, 0xffff0000, v71
    v_pk_fma_f32 v[40:41], v[56:57], v[20:21], v[40:41] op_sel:[0,1,0] op_sel_hi:[1,1,1]
    v_pk_fma_f32 v[42:43], v[58:59], v[20:21], v[42:43] op_sel:[0,1,0] op_sel_hi:[1,1,1]
    v_pk_fma_f32 v[44:45], v[60:61], v[20:21], v[44:45] op_sel:[0,1,0] op_sel_hi:[1,1,1]
    v_pk_fma_f32 v[46:47], v[62:63], v[20:21], v[46:47] op_sel:[0,1,0] op_sel_hi:[1,1,1]
    v_pk_fma_f32 v[48:49], v[56:57], v[28:29], v[48:49] op_sel:[0,1,0] op_sel_hi:[1,1,1]
    v_pk_fma_f32 v[50:51], v[58:59], v[28:29], v[50:51] op_sel:[0,1,0] op_sel_hi:[1,1,1]
    v_pk_fma_f32 v[52:53], v[60:61], v[28:29], v[52:53] op_sel:[0,1,0] op_sel_hi:[1,1,1]
    v_pk_fma_f32 v[54:55], v[62:63], v[28:29], v[54:55] op_sel:[0,1,0] op_sel_hi:[1,1,1]
    s_waitcnt vmcnt(4)
    v_lshlrev_b32 v56, 16, v72
    v_and_b32 v57, 0xffff0000, v72
    v_lshlrev_b32 v58, 16, v73
    v_and_b32 v59, 0xffff0000, v73
    v_lshlrev_b32 v60, 16, v74
    v_and_b32 v61, 0xffff0000, v74
    v_lshlrev_b32 v62, 16, v75
    v_and_b32 v63, 0xffff0000, v75
    v_pk_fma_f32 v[40:41], v[56:57], v[22:23], v[40:41] op_sel:[0,0,0] op_sel_hi:[1,0,1]
    v_pk_fma_f32 v[42:43], v[58:59], v[22:23], v[42:43] op_sel:[0,0,0] op_sel_hi:[1,0,1]
    v_pk_fma_f32 v[44:45], v[60:61], v[22:23], v[44:45] op_sel:[0,0,0] op_sel_hi:[1,0,1]
    v_pk_fma_f32 v[46:47], v[62:63], v[22:23], v[46:47] op_sel:[0,0,0] op_sel_hi:[1,0,1]
    v_pk_fma_f32 v[48:49], v[56:57], v[30:31], v[48:49] op_sel:[0,0,0] op_sel_hi:[1,0,1]
    v_pk_fma_f32 v[50:51], v[58:59], v[30:31], v[50:51] op_sel:[0,0,0] op_sel_hi:[1,0,1]
    v_pk_fma_f32 v[52:53], v[60:61], v[30:31], v[52:53] op_sel:[0,0,0] op_sel_hi:[1,0,1]
    v_pk_fma_f32 v[54:55], v[62:63], v[30:31], v[54:55] op_sel:[0,0,0] op_sel_hi:[1,0,1]
    s_waitcnt vmcnt(3)
    v_lshlrev_b32 v56, 16, v76
    v_and_b32 v57, 0xffff0000, v76
    v_lshlrev_b32 v58, 16, v77
    v_and_b32 v59, 0xffff0000, v77
    v_lshlrev_b32 v60, 16, v78
    v_and_b32 v61, 0xffff0000, v78
    v_lshlrev_b32 v62, 16, v79
    v_and_b32 v63, 0xffff0000, v79
    v_pk_fma_f32 v[40:41], v[56:57], v[22:23], v[40:41] op_sel:[0,1,0] op_sel_hi:[1,1,1]
    v_pk_fma_f32 v[42:43], v[58:59], v[22:23], v[42:43] op_sel:[0,1,0] op_sel_hi:[1,1,1]
    v_pk_fma_f32 v[44:45], v[60:61], v[22:23], v[44:45] op_sel:[0,1,0] op_sel_hi:[1,1,1]
    v_pk_fma_f32 v[46:47], v[62:63], v[22:23], v[46:47] op_sel:[0,1,0] op_sel_hi:[1,1,1]
    v_pk_fma_f32 v[48:49], v[56:57], v[30:31], v[48:49] op_sel:[0,1,0] op_sel_hi:[1,1,1]
    v_pk_fma_f32 v[50:51], v[58:59], v[30:31], v[50:51] op_sel:[0,1,0] op_sel_hi:[1,1,1]
    v_pk_fma_f32 v[52:53], v[60:61], v[30:31], v[52:53] op_sel:[0,1,0] op_sel_hi:[1,1,1]
    v_pk_fma_f32 v[54:55], v[62:63], v[30:31], v[54:55] op_sel:[0,1,0] op_sel_hi:[1,1,1]
    s_waitcnt vmcnt(2)
    v_lshlrev_b32 v56, 16, v80
    v_and_b32 v57, 0xffff0000, v80
    v_lshlrev_b32 v58, 16, v81
    v_and_b32 v59, 0xffff0000, v81
    v_lshlrev_b32 v60, 16, v82
    v_and_b32 v61, 0xffff0000, v82
    v_lshlrev_b32 v62, 16, v83
    v_and_b32 v63, 0xffff0000, v83
    v_pk_fma_f32 v[40:41], v[56:57], v[24:25], v[40:41] op_sel:[0,0,0] op_sel_hi:[1,0,1]
    v_pk_fma_f32 v[42:43], v[58:59], v[24:25], v[42:43] op_sel:[0,0,0] op_sel_hi:[1,0,1]
    v_pk_fma_f32 v[44:45], v[60:61], v[24:25], v[44:45] op_sel:[0,0,0] op_sel_hi:[1,0,1]
    v_pk_fma_f32 v[46:47], v[62:63], v[24:25], v[46:47] op_sel:[0,0,0] op_sel_hi:[1,0,1]
    v_pk_fma_f32 v[48:49], v[56:57], v[32:33], v[48:49] op_sel:[0,0,0] op_sel_hi:[1,0,1]
    v_pk_fma_f32 v[50:51], v[58:59], v[32:33], v[50:51] op_sel:[0,0,0] op_sel_hi:[1,0,1]
    v_pk_fma_f32 v[52:53], v[60:61], v[32:33], v[52:53] op_sel:[0,0,0] op_sel_hi:[1,0,1]
    v_pk_fma_f32 v[54:55], v[62:63], v[32:33], v[54:55] op_sel:[0,0,0] op_sel_hi:[1,0,1]
    s_waitcnt vmcnt(1)
    v_lshlrev_b32 v56, 16, v84
    v_and_b32 v57, 0xffff0000, v84
    v_lshlrev_b32 v58, 16, v85
    v_and_b32 v59, 0xffff0000, v85
    v_lshlrev_b32 v60, 16, v86
    v_and_b32 v61, 0xffff0000, v86
    v_lshlrev_b32 v62, 16, v87
    v_and_b32 v63, 0xffff0000, v87
    v_pk_fma_f32 v[40:41], v[56:57], v[24:25], v[40:41] op_sel:[0,1,0] op_sel_hi:[1,1,1]
    v_pk_fma_f32 v[42:43], v[58:59], v[24:25], v[42:43] op_sel:[0,1,0] op_sel_hi:[1,1,1]
    v_pk_fma_f32 v[44:45], v[60:61], v[24:25], v[44:45] op_sel:[0,1,0] op_sel_hi:[1,1,1]
    v_pk_fma_f32 v[46:47], v[62:63], v[24:25], v[46:47] op_sel:[0,1,0] op_sel_hi:[1,1,1]
    v_pk_fma_f32 v[48:49], v[56:57], v[32:33], v[48:49] op_sel:[0,1,0] op_sel_hi:[1,1,1]
    v_pk_fma_f32 v[50:51], v[58:59], v[32:33], v[50:51] op_sel:[0,1,0] op_sel_hi:[1,1,1]
    v_pk_fma_f32 v[52:53], v[60:61], v[32:33], v[52:53] op_sel:[0,1,0] op_sel_hi:[1,1,1]
    v_pk_fma_f32 v[54:55], v[62:63], v[32:33], v[54:55] op_sel:[0,1,0] op_sel_hi:[1,1,1]
    s_waitcnt vmcnt(0)
    v_lshlrev_b32 v56, 16, v88
    v_and_b32 v57, 0xffff0000, v88
    v_lshlrev_b32 v58, 16, v89
    v_and_b32 v59, 0xffff0000, v89
    v_lshlrev_b32 v60, 16, v90
    v_and_b32 v61, 0xffff0000, v90
    v_lshlrev_b32 v62, 16, v91
    v_and_b32 v63, 0xffff0000, v91
    v_pk_fma_f32 v[40:41], v[56:57], v[26:27], v[40:41] op_sel:[0,0,0] op_sel_hi:[1,0,1]
    v_pk_fma_f32 v[42:43], v[58:59], v[26:27], v[42:43] op_sel:[0,0,0] op_sel_hi:[1,0,1]
    v_pk_fma_f32 v[44:45], v[60:61], v[26:27], v[44:45] op_sel:[0,0,0] op_sel_hi:[1,0,1]
    v_pk_fma_f32 v[46:47], v[62:63], v[26:27], v[46:47] op_sel:[0,0,0] op_sel_hi:[1,0,1]
    v_pk_fma_f32 v[48:49], v[56:57], v[34:35], v[48:49] op_sel:[0,0,0] op_sel_hi:[1,0,1]
    v_pk_fma_f32 v[50:51], v[58:59], v[34:35], v[50:51] op_sel:[0,0,0] op_sel_hi:[1,0,1]
    v_pk_fma_f32 v[52:53], v[60:61], v[34:35], v[52:53] op_sel:[0,0,0] op_sel_hi:[1,0,1]
    v_pk_fma_f32 v[54:55], v[62:63], v[34:35], v[54:55] op_sel:[0,0,0] op_sel_hi:[1,0,1]
    v_permlane32_swap_b32 v40, v48
    v_permlane32_swap_b32 v41, v49
    v_permlane32_swap_b32 v42, v50
    v_permlane32_swap_b32 v43, v51
    v_permlane32_swap_b32 v44, v52
    v_permlane32_swap_b32 v45, v53
    v_permlane32_swap_b32 v46, v54
    v_permlane32_swap_b32 v47, v55
    v_add_f32 v40, v40, v48
    v_add_f32 v41, v41, v49
    v_add_f32 v42, v42, v50
    v_add_f32 v43, v43, v51
    v_add_f32 v44, v44, v52
    v_add_f32 v45, v45, v53
    v_add_f32 v46, v46, v54
    v_add_f32 v47, v47, v55
    v_permlane16_swap_b32 v40, v44
    v_permlane16_swap_b32 v41, v45
    v_permlane16_swap_b32 v42, v46
    v_permlane16_swap_b32 v43, v47
    v_add_f32 v40, v40, v44
    v_add_f32 v41, v41, v45
    v_add_f32 v42, v42, v46
    v_add_f32 v43, v43, v47
    v_and_b32 v7, 7, v1
    v_lshlrev_b32 v7, 5, v7
    v_lshl_add_u32 v7, v6, 8, v7
    v_bfe_u32 v8, v1, 4, 1
    v_lshl_add_u32 v7, v8, 4, v7
    s_lshl_b32 s72, s28, 9
    v_add_u32 v7, s72, v7
    v_add_f32_dpp v40, v40, v40 row_ror:8 row_mask:0xf bank_mask:0xf
    v_add_f32_dpp v41, v41, v41 row_ror:8 row_mask:0xf bank_mask:0xf
    v_add_f32_dpp v42, v42, v42 row_ror:8 row_mask:0xf bank_mask:0xf
    v_add_f32_dpp v43, v43, v43 row_ror:8 row_mask:0xf bank_mask:0xf
    s_mov_b32 exec_lo, 0x00ff00ff
    s_mov_b32 exec_hi, 0x00ff00ff
    ds_write_b128 v7, v[40:43] offset:24576
    s_mov_b64 exec, 1
    v_mov_b32 v4, 1
    s_waitcnt lgkmcnt(0)
    ds_add_rtn_u32 v8, v3, v4
    s_mov_b64 exec, -1
    s_and_b32 s72, s33, 0xff
    v_mov_b32 v16, s72
    s_bfe_u32 s72, s33, 0x80008
    v_mov_b32 v17, s72
    s_bfe_u32 s72, s33, 0x80010
    v_mov_b32 v18, s72
    s_lshr_b32 s72, s33, 24
    v_mov_b32 v19, s72
    v_mov_b32 v28, s33
    s_mov_b32 s70, 0xffffff00
    s_waitcnt lgkmcnt(0)
    v_readfirstlane_b32 s72, v8
    s_mov_b32 exec_hi, 0
    s_cmp_eq_u32 s72, 3
    s_cbranch_scc0 L_h_nopub
    v_lshlrev_b32 v7, 4, v1
    ds_read_b128 v[40:43], v7 offset:24576
    ds_read_b128 v[44:47], v7 offset:25088
    ds_read_b128 v[48:51], v7 offset:25600
    ds_read_b128 v[52:55], v7 offset:26112
    s_lshl_b32 s72, s29, 13
    s_lshl_b32 s73, s66, 11
    s_add_u32 s72, s72, s73
    s_and_b32 s73, s35, 7
    s_lshl_b32 s73, s73, 8
    s_add_u32 s72, s72, s73
    s_add_u32 s72, s72, 262144
    s_lshl_b32 s73, s67, 13
    s_lshl_b32 s74, s35, 8
    s_add_u32 s73, s73, s74
    s_add_u32 s73, s73, 327680
    s_cmp_lt_u32 s34, 112
    s_cselect_b32 s73, s73, 360192
    s_cmp_eq_u32 s31, 0
    s_cselect_b32 s72, s72, s73
    s_cselect_b32 s73, 12, 15
    v_lshrrev_b32 v8, 4, v1
    v_lshlrev_b32 v8, s73, v8
    v_and_b32 v7, 15, v1
    v_lshl_add_u32 v8, v7, 4, v8
    v_add_u32 v8, s72, v8
    v_mov_b32 v60, s64
    v_mov_b32 v61, s33
    v_mov_b32 v62, s64
    v_mov_b32 v63, s33
    s_lshl_b32 s73, s29, 9
    s_lshl_b32 s72, s30, 4
    s_add_u32 s72, s72, s73
    s_add_u32 s72, s72, 139264
    v_mov_b32 v7, s72
    s_waitcnt lgkmcnt(0)
    v_pk_add_f32 v[40:41], v[40:41], v[44:45]
    v_pk_add_f32 v[42:43], v[42:43], v[46:47]
    v_pk_add_f32 v[48:49], v[48:49], v[52:53]
    v_pk_add_f32 v[50:51], v[50:51], v[54:55]
    v_pk_add_f32 v[40:41], v[40:41], v[48:49]
    v_pk_add_f32 v[42:43], v[42:43], v[50:51]
    v_add_u32 v40, 0x80, v40
    v_add_u32 v41, 0x80, v41
    v_add_u32 v42, 0x80, v42
    v_add_u32 v43, 0x80, v43
    v_bfi_b32 v40, s70, v40, v16
    v_bfi_b32 v41, s70, v41, v17
    v_bfi_b32 v42, s70, v42, v18
    v_bfi_b32 v43, s70, v43, v19
    global_store_dwordx4 v8, v[40:43], s[26:27] sc1
    s_mov_b64 exec, 1
    global_store_dwordx4 v7, v[60:63], s[26:27] sc1
L_h_nopub:
    s_mov_b64 exec, -1
    s_cmp_eq_u32 s28, 0
    s_cbranch_scc0 L_h_nq
    v_mov_b32 v7, 5132
    s_mov_b32 s96, 0
    s_branch L_lw_qt
L_lwr_qt:
    s_sleep 1
    s_add_u32 s96, s96, 1
    s_cmp_lt_u32 s96, 4194304
    s_cbranch_scc1 L_lw_qt
    s_endpgm
L_lw_qt:
    ds_read_b32 v8, v7
    s_waitcnt lgkmcnt(0)
    v_readfirstlane_b32 s76, v8
    s_nop 0
    s_cmp_ge_u32 s76, 1
    s_cbranch_scc0 L_lwr_qt
    s_lshl_b32 s72, s29, 13
    s_lshl_b32 s73, s31, 12
    s_add_u32 s72, s72, s73
    s_add_u32 s72, s72, 262144
    s_add_u32 s74, s26, s72
    s_addc_u32 s75, s27, 0
    v_lshlrev_b32 v7, 4, v1
    s_lshl_b32 s72, s29, 9
    s_add_u32 s72, s72, 139264
    v_lshl_add_u32 v8, v5, 4, s72
    s_mov_b32 s96, 0
    s_mov_b64 s[78:79], exec
L_poll_q:
    global_load_dwordx4 v[40:43], v7, s[74:75] offset:0 sc1
    global_load_dwordx4 v[44:47], v7, s[74:75] offset:1024 sc1
    global_load_dwordx4 v[48:51], v7, s[74:75] offset:2048 sc1
    global_load_dwordx4 v[52:55], v7, s[74:75] offset:3072 sc1
    global_load_dwordx4 v[60:63], v8, s[26:27] sc1
    s_waitcnt vmcnt(0)
L_chk_q:
    v_xor_b32 v56, v40, v16
    v_xor_b32 v57, v41, v17
    v_xor_b32 v58, v42, v18
    v_or3_b32 v56, v56, v57, v58
    v_xor_b32 v57, v43, v19
    v_xor_b32 v58, v44, v16
    v_or3_b32 v56, v56, v57, v58
    v_xor_b32 v57, v45, v17
    v_xor_b32 v58, v46, v18
    v_or3_b32 v56, v56, v57, v58
    v_xor_b32 v57, v47, v19
    v_xor_b32 v58, v48, v16
    v_or3_b32 v56, v56, v57, v58
    v_xor_b32 v57, v49, v17
    v_xor_b32 v58, v50, v18
    v_or3_b32 v56, v56, v57, v58
    v_xor_b32 v57, v51, v19
    v_xor_b32 v58, v52, v16
    v_or3_b32 v56, v56, v57, v58
    v_xor_b32 v57, v53, v17
    v_xor_b32 v58, v54, v18
    v_or3_b32 v56, v56, v57, v58
    v_xor_b32 v57, v55, v19
    v_or_b32 v56, v56, v57
    v_and_b32 v56, 0xff, v56
    v_xor_b32 v57, v61, v28
    v_xor_b32 v58, v63, v28
    v_or3_b32 v56, v56, v57, v58
    v_cmp_ne_u32 vcc, 0, v56
    s_nop 0
    s_cmp_lg_u64 vcc, 0
    s_cbranch_scc0 L_got_q
    s_bcnt1_i32_b64 s76, vcc
    s_cmp_gt_u32 s76, 16
    s_cbranch_scc0 L_short_q
    s_sleep 4
L_short_q:
    s_add_u32 s96, s96, 1
    s_cmp_lt_u32 s96, 524288
    s_cbranch_scc1 L_poll_q
    s_endpgm
L_got_q:
    s_mov_b64 exec, s[78:79]
    v_and_b32 v40, s70, v40
    v_and_b32 v41, s70, v41
    v_and_b32 v42, s70, v42
    v_and_b32 v43, s70, v43
    v_and_b32 v44, s70, v44
    v_and_b32 v45, s70, v45
    v_and_b32 v46, s70, v46
    v_and_b32 v47, s70, v47
    v_and_b32 v48, s70, v48
    v_and_b32 v49, s70, v49
    v_and_b32 v50, s70, v50
    v_and_b32 v51, s70, v51
    v_and_b32 v52, s70, v52
    v_and_b32 v53, s70, v53
    v_and_b32 v54, s70, v54
    v_and_b32 v55, s70, v55
    v_pk_add_f32 v[40:41], v[40:41], v[48:49]
    v_pk_add_f32 v[42:43], v[42:43], v[50:51]
    v_pk_add_f32 v[44:45], v[44:45], v[52:53]
    v_pk_add_f32 v[46:47], v[46:47], v[54:55]
    v_cvt_pk_bf16_f32 v48, v40, v41
    v_cvt_pk_bf16_f32 v49, v42, v43
    v_cvt_pk_bf16_f32 v50, v44, v45
    v_cvt_pk_bf16_f32 v51, v46, v47
    v_lshlrev_b32 v7, 3, v1
    ds_write_b64 v7, v[48:49] offset:5376
    ds_write_b64 v7, v[50:51] offset:5888
    v_cmp_ne_u32 vcc, s64, v60
    s_nop 0
    s_cmp_eq_u64 vcc, 0
    s_cselect_b32 s72, 2, 1
    v_mov_b32 v4, s72
    ds_write_b32 v3, v28 offset:20
    s_waitcnt lgkmcnt(0)
    ds_write_b32 v3, v4 offset:4
L_h_nq:
    s_lshl_b32 s72, s28, 9
    v_lshl_add_u32 v10, v5, 4, s72
    s_lshl_b32 s72, s29, 4
    s_lshl_b32 s73, s28, 2
    s_add_u32 s72, s72, s73
    s_lshl_b32 s72, s72, 12
    s_lshl_b32 s73, s30, 7
    s_add_u32 s72, s72, s73
    s_add_u32 s72, s72, 524288
    v_lshrrev_b32 v11, 3, v5
    v_lshl_add_u32 v11, v11, 12, s72
    v_and_b32 v12, 7, v1
    v_lshl_add_u32 v11, v12, 4, v11
    s_lshl_b32 s72, s29, 5
    s_lshl_b32 s73, s28, 3
    s_add_u32 s72, s72, s73
    s_lshl_b32 s72, s72, 5
    s_add_u32 s72, s72, s30
    s_lshl_b32 s72, s72, 2
    s_add_u32 s72, s72, 196608
    v_lshl_add_u32 v12, v1, 7, s72
    s_lshr_b32 s73, s30, 1
    s_lshl_b32 s34, s73, 3
    s_add_u32 s34, s34, s29
    s_and_b32 s73, s30, 1
    s_lshr_b32 s72, s28, 1
    s_and_b32 s74, s28, 1
    s_lshl_b32 s75, s72, 10
    s_mul_i32 s76, s74, 448
    s_add_u32 s75, s75, s76
    v_lshl_add_u32 v14, v5, 4, s75
    s_lshl_b32 s72, s72, 1
    s_add_u32 s72, s72, s73
    s_lshl_b32 s72, s72, 7
    s_add_u32 s72, s72, s34
    s_mul_i32 s72, s72, 896
    s_add_u32 s72, s72, s76
    s_add_u32 s72, s72, 1048576
    v_lshl_add_u32 v15, v5, 4, s72
    v_mov_b32 v7, 5128
    s_mov_b32 s96, 0
    s_branch L_lw_ml
L_lwr_ml:
    s_sleep 1
    s_add_u32 s96, s96, 1
    s_cmp_lt_u32 s96, 4194304
    s_cbranch_scc1 L_lw_ml
    s_endpgm
L_lw_ml:
    ds_read_b32 v8, v7
    s_waitcnt lgkmcnt(0)
    v_readfirstlane_b32 s76, v8
    s_nop 0
    s_cmp_ge_u32 s76, 4
    s_cbranch_scc0 L_lwr_ml
    s_lshr_b32 s35, s28, 1
    s_lshl_b32 s72, s35, 5
    v_mov_b32 v7, s72
    ds_read_b128 v[40:43], v7 offset:6400
    ds_read_b128 v[44:47], v7 offset:6416
    ds_read_b32 v8, v3 offset:4
    s_mov_b32 s73, 0x3db8aa3b
    s_waitcnt lgkmcnt(0)
    v_readfirstlane_b32 s97, v8
    v_max3_f32 v48, v40, v42, v44
    v_max_f32 v48, v48, v46
    v_sub_f32 v40, v40, v48
    v_sub_f32 v42, v42, v48
    v_sub_f32 v44, v44, v48
    v_sub_f32 v46, v46, v48
    v_mul_f32 v40, s73, v40
    v_mul_f32 v42, s73, v42
    v_mul_f32 v44, s73, v44
    v_mul_f32 v46, s73, v46
    v_exp_f32 v20, v40
    v_exp_f32 v22, v42
    v_exp_f32 v24, v44
    v_exp_f32 v26, v46
    v_mul_f32 v50, v20, v41
    v_fma_f32 v50, v22, v43, v50
    v_fma_f32 v50, v24, v45, v50
    v_fma_f32 v50, v26, v47, v50
    v_mov_b32 v49, s33
    v_mov_b32 v51, s33
    s_bitcmp1_b32 s28, 0
    s_cbranch_scc1 L_h_odd
    s_lshl_b32 s72, s29, 1
    s_add_u32 s72, s72, s35
    s_lshl_b32 s72, s72, 5
    s_add_u32 s72, s72, s30
    s_lshl_b32 s72, s72, 4
    s_add_u32 s72, s72, 131072
    v_mov_b32 v7, s72
    s_mov_b64 exec, 1
    global_store_dwordx4 v7, v[48:51], s[26:27] sc1
    s_mov_b64 exec, -1
    s_cmp_eq_u32 s97, 2
    s_cbranch_scc0 L_h_t2
    s_cmp_eq_u32 s28, 0
    s_cbranch_scc0 L_h_t2
    s_lshl_b32 s35, s29, 5
    s_add_u32 s35, s35, s30
    s_lshl_b32 s72, s35, 7
    s_add_u32 s72, s72, 196608
    s_add_u32 s74, s26, s72
    s_addc_u32 s75, s27, 0
    s_load_dword s36, s[74:75], 0
    s_load_dword s37, s[74:75], 64
    s_lshl_b32 s72, s35, 11
    s_add_u32 s72, s72, 524288
    s_add_u32 s74, s26, s72
    s_addc_u32 s75, s27, 0
    s_load_dword s68, s[74:75], 0
    s_load_dword s69, s[74:75], 64
    s_load_dword s38, s[74:75], 128
    s_load_dword s39, s[74:75], 192
    s_load_dword s40, s[74:75], 256
    s_load_dword s41, s[74:75], 320
    s_load_dword s42, s[74:75], 384
    s_load_dword s43, s[74:75], 448
    s_load_dword s44, s[74:75], 512
    s_load_dword s45, s[74:75], 576
    s_load_dword s46, s[74:75], 640
    s_load_dword s47, s[74:75], 704
    s_load_dword s48, s[74:75], 768
    s_load_dword s49, s[74:75], 832
    s_load_dword s50, s[74:75], 896
    s_load_dword s51, s[74:75], 960
    s_load_dword s52, s[74:75], 1024
    s_load_dword s53, s[74:75], 1088
    s_load_dword s54, s[74:75], 1152
    s_load_dword s55, s[74:75], 1216
    s_load_dword s56, s[74:75], 1280
    s_load_dword s57, s[74:75], 1344
    s_load_dword s58, s[74:75], 1408
    s_load_dword s59, s[74:75], 1472
    s_load_dword s60, s[74:75], 1536
    s_load_dword s61, s[74:75], 1600
    s_load_dword s62, s[74:75], 1664
    s_load_dword s63, s[74:75], 1728
    s_load_dword s64, s[74:75], 1792
    s_load_dword s65, s[74:75], 1856
    s_load_dword s66, s[74:75], 1920
    s_load_dword s67, s[74:75], 1984
    s_waitcnt lgkmcnt(0)
L_h_t2:
    s_branch L_h_b3
L_h_odd:
    s_cmp_eq_u32 s28, 1
    s_cbranch_scc0 L_h_3
    v_lshlrev_b32 v9, 2, v5
    v_mov_b32 v40, 0
    s_cmp_lt_u32 s34, 112
    s_cbranch_scc0 L_h_hzero
    s_lshl_b32 s72, s34, 6
    s_add_u32 s72, s72, 327680
    v_bfe_u32 v7, v1, 4, 1
    v_lshl_add_u32 v7, v7, 15, s72
    v_lshl_add_u32 v7, v6, 13, v7
    v_and_b32 v8, 15, v1
    v_lshl_add_u32 v7, v8, 2, v7
    v_add_u32 v8, 0x4000, v7
    v_and_b32 v46, 3, v1
    v_lshlrev_b32 v46, 3, v46
    v_lshrrev_b32 v46, v46, s33
    s_mov_b32 s96, 0
    s_mov_b64 s[78:79], exec
L_poll_ffn:
    global_load_dword v40, v7, s[26:27] sc1
    global_load_dword v44, v8, s[26:27] sc1
    s_waitcnt vmcnt(0)
L_chk_ffn:
    v_xor_b32 v41, v40, v46
    v_xor_b32 v42, v44, v46
    v_or_b32 v41, v41, v42
    v_and_b32 v41, 0xff, v41
    v_cmp_ne_u32 vcc, 0, v41
    s_nop 0
    s_cmp_lg_u64 vcc, 0
    s_cbranch_scc0 L_got_ffn
    s_bcnt1_i32_b64 s76, vcc
    s_cmp_gt_u32 s76, 16
    s_cbranch_scc0 L_short_ffn
    s_sleep 4
L_short_ffn:
    s_add_u32 s96, s96, 1
    s_cmp_lt_u32 s96, 524288
    s_cbranch_scc1 L_poll_ffn
    s_endpgm
L_got_ffn:
    s_mov_b64 exec, s[78:79]
    v_and_b32 v40, s70, v40
    v_and_b32 v44, s70, v44
    v_mov_b32 v41, v40
    v_mov_b32 v45, v44
    s_nop 0
    v_permlane32_swap_b32 v40, v41
    v_permlane32_swap_b32 v44, v45
    v_add_f32 v40, v40, v41
    v_add_f32 v44, v44, v45
    v_cvt_pk_bf16_f32 v40, v40, v44
    v_and_b32 v44, 0xffff0000, v40
    v_lshlrev_b32 v40, 16, v40
    v_mul_f32 v41, v40, v40
    v_mul_f32 v41, v41, v40
    v_mul_f32 v41, 0x3d372713, v41
    v_add_f32 v41, v41, v40
    v_mul_f32 v41, 0xc0135761, v41
    v_exp_f32 v41, v41
    s_nop 0
    v_add_f32 v41, 1.0, v41
    v_rcp_f32 v41, v41
    s_nop 0
    v_mul_f32 v40, v40, v41
    v_cvt_pk_bf16_f32 v40, v40, v40
    v_lshlrev_b32 v40, 16, v40
    v_mul_f32 v40, v40, v44
    v_cvt_pk_bf16_f32 v40, v40, v40
L_h_hzero:
    ds_write_b32 v9, v40 offset:6656
    s_lshl_b32 s72, s29, 1
    s_add_u32 s72, s72, s31
    s_lshl_b32 s72, s72, 9
    s_add_u32 s72, s72, 131072
    v_lshl_add_u32 v29, v5, 4, s72
    s_waitcnt lgkmcnt(0)
    s_branch L_h_b3
L_h_3:
    s_cmp_eq_u32 s2, 0
    s_cbranch_scc0 L_h_b3
    v_lshlrev_b32 v7, 4, v1
    v_add_u32 v7, 139264, v7
    s_mov_b32 s96, 0
    s_mov_b64 s[78:79], exec
L_poll_ep:
    global_load_dwordx4 v[40:43], v7, s[26:27] offset:0 sc1
    global_load_dwordx4 v[44:47], v7, s[26:27] offset:1024 sc1
    global_load_dwordx4 v[48:51], v7, s[26:27] offset:2048 sc1
    global_load_dwordx4 v[52:55], v7, s[26:27] offset:3072 sc1
    s_waitcnt vmcnt(0)
L_chk_ep:
    v_cmp_ne_u32 vcc, s33, v41
    v_cmp_ne_u32 s[76:77], s33, v43
    s_nop 0
    s_or_b64 vcc, vcc, s[76:77]
    v_cmp_ne_u32 s[76:77], s33, v45
    s_nop 0
    s_or_b64 vcc, vcc, s[76:77]
    v_cmp_ne_u32 s[76:77], s33, v47
    s_nop 0
    s_or_b64 vcc, vcc, s[76:77]
    v_cmp_ne_u32 s[76:77], s33, v49
    s_nop 0
    s_or_b64 vcc, vcc, s[76:77]
    v_cmp_ne_u32 s[76:77], s33, v51
    s_nop 0
    s_or_b64 vcc, vcc, s[76:77]
    v_cmp_ne_u32 s[76:77], s33, v53
    s_nop 0
    s_or_b64 vcc, vcc, s[76:77]
    v_cmp_ne_u32 s[76:77], s33, v55
    s_nop 0
    s_or_b64 vcc, vcc, s[76:77]
    s_cbranch_scc0 L_got_ep
    s_mov_b64 exec, vcc
    s_bcnt1_i32_b64 s76, exec
    s_cmp_gt_u32 s76, 16
    s_cbranch_scc0 L_short_ep
    s_sleep 4
L_short_ep:
    s_add_u32 s96, s96, 1
    s_cmp_lt_u32 s96, 524288
    s_cbranch_scc1 L_poll_ep
    s_endpgm
L_got_ep:
    s_mov_b64 exec, s[78:79]
    v_mov_b32 v7, 0
    s_mov_b64 exec, 1
    global_store_dword v7, v28, s[26:27] sc1
    s_mov_b64 exec, -1
L_h_b3:
    s_mov_b32 exec_hi, 0
    s_barrier
    ds_read_b128 v[44:47], v10 offset:8192
    ds_read_b128 v[48:51], v10 offset:10240
    ds_read_b128 v[52:55], v10 offset:12288
    ds_read_b128 v[56:59], v10 offset:14336
    s_cmp_eq_u32 s28, 1
    s_cbranch_scc0 L_h_noml
    global_load_dwordx4 v[32:35], v29, s[26:27] sc1
L_h_noml:
    s_waitcnt lgkmcnt(3)
    v_pk_mul_f32 v[40:41], v[44:45], v[20:21] op_sel_hi:[1,0]
    v_pk_mul_f32 v[42:43], v[46:47], v[20:21] op_sel_hi:[1,0]
    s_waitcnt lgkmcnt(2)
    v_pk_fma_f32 v[40:41], v[48:49], v[22:23], v[40:41] op_sel_hi:[1,0,1]
    v_pk_fma_f32 v[42:43], v[50:51], v[22:23], v[42:43] op_sel_hi:[1,0,1]
    s_waitcnt lgkmcnt(1)
    v_pk_fma_f32 v[40:41], v[52:53], v[24:25], v[40:41] op_sel_hi:[1,0,1]
    v_pk_fma_f32 v[42:43], v[54:55], v[24:25], v[42:43] op_sel_hi:[1,0,1]
    s_waitcnt lgkmcnt(0)
    v_pk_fma_f32 v[40:41], v[56:57], v[26:27], v[40:41] op_sel_hi:[1,0,1]
    v_pk_fma_f32 v[42:43], v[58:59], v[26:27], v[42:43] op_sel_hi:[1,0,1]
    v_bfi_b32 v40, s70, v40, v16
    v_bfi_b32 v41, s70, v41, v17
    v_bfi_b32 v42, s70, v42, v18
    v_bfi_b32 v43, s70, v43, v19
    s_cmp_eq_u32 s97, 2
    s_cbranch_scc0 L_sp2_go
    global_store_dwordx4 v11, v[40:43], s[26:27]
    s_mov_b64 exec, 0xff
    s_nop 0
    global_store_dword v12, v28, s[26:27]
    s_branch L_j2_go
L_sp2_go:
    global_store_dwordx4 v11, v[40:43], s[26:27] sc1
    s_mov_b64 exec, 0xff
    global_store_dword v12, v28, s[26:27] sc1
L_j2_go:
    s_mov_b32 exec_lo, -1
    s_cmp_eq_u32 s28, 1
    s_cbranch_scc0 L_h_b4
    s_mov_b32 s96, 0
    s_mov_b64 s[78:79], exec
    s_waitcnt vmcnt(2)
    s_branch L_chk_ml
L_poll_ml:
    global_load_dwordx4 v[32:35], v29, s[26:27] sc1
    s_waitcnt vmcnt(0)
L_chk_ml:
    v_cmp_ne_u32 vcc, s33, v33
    v_cmp_ne_u32 s[76:77], s33, v35
    s_nop 0
    s_or_b64 vcc, vcc, s[76:77]
    s_cbranch_scc0 L_got_ml
    s_mov_b64 exec, vcc
    s_bcnt1_i32_b64 s76, exec
    s_cmp_gt_u32 s76, 16
    s_cbranch_scc0 L_short_ml
    s_sleep 4
L_short_ml:
    s_add_u32 s96, s96, 1
    s_cmp_lt_u32 s96, 524288
    s_cbranch_scc1 L_poll_ml
    s_endpgm
L_got_ml:
    s_mov_b64 exec, s[78:79]
    v_mov_b32 v44, v32
    s_nop 1
    v_max_f32_dpp v44, v44, v44 quad_perm:[1,0,3,2] row_mask:0xf bank_mask:0xf
    s_nop 1
    v_max_f32_dpp v44, v44, v44 quad_perm:[2,3,0,1] row_mask:0xf bank_mask:0xf
    s_nop 1
    v_max_f32_dpp v44, v44, v44 row_half_mirror row_mask:0xf bank_mask:0xf
    s_nop 1
    v_max_f32_dpp v44, v44, v44 row_mirror row_mask:0xf bank_mask:0xf
    v_sub_f32 v32, v32, v44
    v_mul_f32 v32, s73, v32
    v_exp_f32 v32, v32
    s_nop 0
    v_mul_f32 v34, v32, v34
    s_nop 1
    v_add_f32_dpp v34, v34, v34 quad_perm:[1,0,3,2] row_mask:0xf bank_mask:0xf
    s_nop 1
    v_add_f32_dpp v34, v34, v34 quad_perm:[2,3,0,1] row_mask:0xf bank_mask:0xf
    s_nop 1
    v_add_f32_dpp v34, v34, v34 row_half_mirror row_mask:0xf bank_mask:0xf
    s_nop 1
    v_add_f32_dpp v34, v34, v34 row_mirror row_mask:0xf bank_mask:0xf
    v_rcp_f32 v35, v34
    v_lshlrev_b32 v8, 2, v5
    v_fma_f32 v44, -v34, v35, 1.0
    v_fma_f32 v35, v44, v35, v35
    v_mul_f32 v32, v32, v35
    ds_write_b32 v8, v32 offset:6528
    v_mov_b32 v4, 1
    ds_write_b32 v3, v4 offset:16
L_h_b4:
    s_mov_b32 exec_lo, 0x0fffffff
    s_barrier
    ds_read_b128 v[44:47], v14 offset:16384
    ds_read_b128 v[48:51], v14 offset:18432
    ds_read_b128 v[52:55], v14 offset:20480
    ds_read_b128 v[56:59], v14 offset:22528
    s_waitcnt lgkmcnt(2)
    v_pk_add_f32 v[44:45], v[44:45], v[48:49]
    v_pk_add_f32 v[46:47], v[46:47], v[50:51]
    s_waitcnt lgkmcnt(0)
    v_pk_add_f32 v[52:53], v[52:53], v[56:57]
    v_pk_add_f32 v[54:55], v[54:55], v[58:59]
    v_pk_add_f32 v[44:45], v[44:45], v[52:53]
    v_pk_add_f32 v[46:47], v[46:47], v[54:55]
    v_bfi_b32 v44, s70, v44, v16
    v_bfi_b32 v45, s70, v45, v17
    v_bfi_b32 v46, s70, v46, v18
    v_bfi_b32 v47, s70, v47, v19
    global_store_dwordx4 v15, v[44:47], s[26:27] sc1
    s_branch L_fin
L_streamer2:
    v_bfe_u32 v7, v1, 3, 1
    v_lshlrev_b32 v7, 9, v7
    v_lshl_add_u32 v7, v4, 6, v7
    v_lshl_add_u32 v7, v5, 4, v7
    v_and_b32 v52, 1, v1
    v_lshlrev_b32 v52, 4, v52
    v_mov_b32 v53, 0xffff
    v_lshlrev_b32 v52, v52, v53
    v_bfe_u32 v53, v1, 1, 2
    v_cmp_eq_u32 vcc, 0, v53
    s_nop 1
    v_cndmask_b32 v8, 0, v52, vcc
    v_cmp_eq_u32 vcc, 1, v53
    s_nop 1
    v_cndmask_b32 v9, 0, v52, vcc
    v_cmp_eq_u32 vcc, 2, v53
    s_nop 1
    v_cndmask_b32 v10, 0, v52, vcc
    v_cmp_eq_u32 vcc, 3, v53
    s_nop 1
    v_cndmask_b32 v11, 0, v52, vcc
    s_mov_b32 s70, 0xf0f0f0f0
    s_mov_b32 s71, 0xf0f0f0f0
    s_lshr_b32 s72, s30, 1
    s_and_b32 s73, s30, 1
    s_mul_i32 s73, s73, 448
    s_lshl_b32 s74, s29, 9
    s_lshl_b32 s75, s72, 5
    s_add_u32 s74, s74, s75
    s_lshl_b32 s75, s28, 3
    s_add_u32 s74, s74, s75
    s_mul_i32 s74, s74, 896
    s_add_u32 s74, s74, s73
    v_mul_u32_u24 v52, 1792, v4
    v_lshl_add_u32 v52, v6, 4, v52
    v_add_u32 v62, s74, v52
    s_lshl_b32 s74, s72, 3
    s_add_u32 s74, s74, s29
    s_lshl_b32 s74, s74, 4
    s_lshl_b32 s75, s28, 2
    s_add_u32 s74, s74, s75
    s_mul_i32 s74, s74, 896
    s_add_u32 s74, s74, s73
    v_mul_u32_u24 v52, 896, v4
    v_lshl_add_u32 v52, v6, 4, v52
    v_add_u32 v63, s74, v52
    s_mov_b32 s44, s12
    s_mov_b32 s45, s13
    s_mov_b32 s46, 3670016
    s_mov_b32 s47, 0x20000
    s_mov_b32 s48, s20
    s_mov_b32 s49, s21
    s_mov_b32 s50, 1605632
    s_mov_b32 s51, 0x20000
    v_mov_b32 v28, 5124
    s_mov_b32 s96, 0
    s_branch L_lw_q
L_lwr_q:
    s_sleep 1
    s_add_u32 s96, s96, 1
    s_cmp_lt_u32 s96, 4194304
    s_cbranch_scc1 L_lw_q
    s_endpgm
L_lw_q:
    ds_read_b32 v53, v28
    s_waitcnt lgkmcnt(0)
    v_readfirstlane_b32 s76, v53
    s_nop 0
    s_cmp_ge_u32 s76, 1
    s_cbranch_scc0 L_lwr_q
    s_mov_b32 s97, s76
    ds_read_b32 v29, v28 offset:16
    ds_read_b128 v[52:55], v7 offset:5376
    ds_read_b128 v[56:59], v7 offset:5632
    s_waitcnt lgkmcnt(1)
    v_readfirstlane_b32 s33, v29
    v_cndmask_b32 v36, v52, 0, s[70:71]
    v_cndmask_b32 v44, 0, v52, s[70:71]
    v_cndmask_b32 v37, v53, 0, s[70:71]
    v_cndmask_b32 v45, 0, v53, s[70:71]
    v_cndmask_b32 v38, v54, 0, s[70:71]
    v_cndmask_b32 v46, 0, v54, s[70:71]
    v_cndmask_b32 v39, v55, 0, s[70:71]
    v_cndmask_b32 v47, 0, v55, s[70:71]
    s_waitcnt lgkmcnt(0)
    v_cndmask_b32 v40, v56, 0, s[70:71]
    v_cndmask_b32 v48, 0, v56, s[70:71]
    v_cndmask_b32 v41, v57, 0, s[70:71]
    v_cndmask_b32 v49, 0, v57, s[70:71]
    v_cndmask_b32 v42, v58, 0, s[70:71]
    v_cndmask_b32 v50, 0, v58, s[70:71]
    v_cndmask_b32 v43, v59, 0, s[70:71]
    v_cndmask_b32 v51, 0, v59, s[70:71]
    s_mov_b32 s98, s33
    s_mov_b32 s99, s33
    v_mfma_f32_16x16x32_bf16 v[28:31], v[64:67], v[36:39], 0
    v_mfma_f32_16x16x32_bf16 v[28:31], v[68:71], v[40:43], v[28:31]
    v_mfma_f32_16x16x32_bf16 v[28:31], v[72:75], v[44:47], v[28:31]
    v_mfma_f32_16x16x32_bf16 v[28:31], v[76:79], v[48:51], v[28:31]
    v_mfma_f32_16x16x32_bf16 v[32:35], v[80:83], v[36:39], 0
    v_mfma_f32_16x16x32_bf16 v[32:35], v[84:87], v[40:43], v[32:35]
    v_mfma_f32_16x16x32_bf16 v[32:35], v[88:91], v[44:47], v[32:35]
    v_mfma_f32_16x16x32_bf16 v[32:35], v[92:95], v[48:51], v[32:35]
    s_nop 3
    v_mov_b32_dpp v52, v28 quad_perm:[0,0,0,0] row_mask:0xf bank_mask:0xf
    v_mov_b32_dpp v53, v30 quad_perm:[2,2,2,2] row_mask:0xf bank_mask:0xf
    s_nop 0
    v_add_f32_dpp v52, v29, v52 quad_perm:[1,1,1,1] row_mask:0xf bank_mask:0xf
    v_add_f32_dpp v53, v31, v53 quad_perm:[3,3,3,3] row_mask:0xf bank_mask:0xf
    v_add_f32 v12, v52, v53
    v_mfma_f32_16x16x32_bf16 v[28:31], v[96:99], v[36:39], 0
    v_mfma_f32_16x16x32_bf16 v[28:31], v[100:103], v[40:43], v[28:31]
    v_mfma_f32_16x16x32_bf16 v[28:31], v[104:107], v[44:47], v[28:31]
    v_mfma_f32_16x16x32_bf16 v[28:31], v[108:111], v[48:51], v[28:31]
    v_mov_b32_dpp v52, v32 quad_perm:[0,0,0,0] row_mask:0xf bank_mask:0xf
    v_mov_b32_dpp v53, v34 quad_perm:[2,2,2,2] row_mask:0xf bank_mask:0xf
    s_nop 0
    v_add_f32_dpp v52, v33, v52 quad_perm:[1,1,1,1] row_mask:0xf bank_mask:0xf
    v_add_f32_dpp v53, v35, v53 quad_perm:[3,3,3,3] row_mask:0xf bank_mask:0xf
    v_add_f32 v13, v52, v53
    v_mfma_f32_16x16x32_bf16 v[32:35], v[112:115], v[36:39], 0
    v_mfma_f32_16x16x32_bf16 v[32:35], v[116:119], v[40:43], v[32:35]
    v_mfma_f32_16x16x32_bf16 v[32:35], v[120:123], v[44:47], v[32:35]
    v_mfma_f32_16x16x32_bf16 v[32:35], v[124:127], v[48:51], v[32:35]
    v_mov_b32_dpp v52, v28 quad_perm:[0,0,0,0] row_mask:0xf bank_mask:0xf
    v_mov_b32_dpp v53, v30 quad_perm:[2,2,2,2] row_mask:0xf bank_mask:0xf
    s_nop 0
    v_add_f32_dpp v52, v29, v52 quad_perm:[1,1,1,1] row_mask:0xf bank_mask:0xf
    v_add_f32_dpp v53, v31, v53 quad_perm:[3,3,3,3] row_mask:0xf bank_mask:0xf
    v_add_f32 v14, v52, v53
    s_waitcnt vmcnt(11)
    buffer_load_dwordx4 v[240:243], v3, s[40:43], s58 offen offset:0 nt
    s_waitcnt vmcnt(11)
    buffer_load_dwordx4 v[244:247], v3, s[40:43], s58 offen offset:256 nt
    s_waitcnt vmcnt(11)
    buffer_load_dwordx4 v[248:251], v3, s[40:43], s59 offen offset:0 nt
    s_waitcnt vmcnt(11)
    buffer_load_dwordx4 v[252:255], v3, s[40:43], s59 offen offset:256 nt
    v_mfma_f32_16x16x32_bf16 v[28:31], v[128:131], v[36:39], 0
    v_mfma_f32_16x16x32_bf16 v[28:31], v[132:135], v[40:43], v[28:31]
    v_mfma_f32_16x16x32_bf16 v[28:31], v[136:139], v[44:47], v[28:31]
    v_mfma_f32_16x16x32_bf16 v[28:31], v[140:143], v[48:51], v[28:31]
    v_mov_b32_dpp v52, v32 quad_perm:[0,0,0,0] row_mask:0xf bank_mask:0xf
    v_mov_b32_dpp v53, v34 quad_perm:[2,2,2,2] row_mask:0xf bank_mask:0xf
    s_nop 0
    v_add_f32_dpp v52, v33, v52 quad_perm:[1,1,1,1] row_mask:0xf bank_mask:0xf
    v_add_f32_dpp v53, v35, v53 quad_perm:[3,3,3,3] row_mask:0xf bank_mask:0xf
    v_add_f32 v15, v52, v53
    v_mfma_f32_16x16x32_bf16 v[32:35], v[144:147], v[36:39], 0
    v_mfma_f32_16x16x32_bf16 v[32:35], v[148:151], v[40:43], v[32:35]
    v_mfma_f32_16x16x32_bf16 v[32:35], v[152:155], v[44:47], v[32:35]
    v_mfma_f32_16x16x32_bf16 v[32:35], v[156:159], v[48:51], v[32:35]
    v_mov_b32_dpp v52, v28 quad_perm:[0,0,0,0] row_mask:0xf bank_mask:0xf
    v_mov_b32_dpp v53, v30 quad_perm:[2,2,2,2] row_mask:0xf bank_mask:0xf
    s_nop 0
    v_add_f32_dpp v52, v29, v52 quad_perm:[1,1,1,1] row_mask:0xf bank_mask:0xf
    v_add_f32_dpp v53, v31, v53 quad_perm:[3,3,3,3] row_mask:0xf bank_mask:0xf
    v_add_f32 v16, v52, v53
    v_mfma_f32_16x16x32_bf16 v[28:31], v[160:163], v[36:39], 0
    v_mfma_f32_16x16x32_bf16 v[28:31], v[164:167], v[40:43], v[28:31]
    v_mfma_f32_16x16x32_bf16 v[28:31], v[168:171], v[44:47], v[28:31]
    v_mfma_f32_16x16x32_bf16 v[28:31], v[172:175], v[48:51], v[28:31]
    v_mov_b32_dpp v52, v32 quad_perm:[0,0,0,0] row_mask:0xf bank_mask:0xf
    v_mov_b32_dpp v53, v34 quad_perm:[2,2,2,2] row_mask:0xf bank_mask:0xf
    s_nop 0
    v_add_f32_dpp v52, v33, v52 quad_perm:[1,1,1,1] row_mask:0xf bank_mask:0xf
    v_add_f32_dpp v53, v35, v53 quad_perm:[3,3,3,3] row_mask:0xf bank_mask:0xf
    v_add_f32 v17, v52, v53
    v_mfma_f32_16x16x32_bf16 v[32:35], v[176:179], v[36:39], 0
    v_mfma_f32_16x16x32_bf16 v[32:35], v[180:183], v[40:43], v[32:35]
    v_mfma_f32_16x16x32_bf16 v[32:35], v[184:187], v[44:47], v[32:35]
    v_mfma_f32_16x16x32_bf16 v[32:35], v[188:191], v[48:51], v[32:35]
    v_mov_b32_dpp v52, v28 quad_perm:[0,0,0,0] row_mask:0xf bank_mask:0xf
    v_mov_b32_dpp v53, v30 quad_perm:[2,2,2,2] row_mask:0xf bank_mask:0xf
    s_nop 0
    v_add_f32_dpp v52, v29, v52 quad_perm:[1,1,1,1] row_mask:0xf bank_mask:0xf
    v_add_f32_dpp v53, v31, v53 quad_perm:[3,3,3,3] row_mask:0xf bank_mask:0xf
    v_add_f32 v18, v52, v53
    s_waitcnt vmcnt(11)
    buffer_load_dwordx4 v[64:67], v3, s[40:43], s60 offen offset:0 nt
    s_waitcnt vmcnt(11)
    buffer_load_dwordx4 v[68:71], v3, s[40:43], s60 offen offset:256 nt
    s_waitcnt vmcnt(11)
    buffer_load_dwordx4 v[72:75], v3, s[40:43], s61 offen offset:0 nt
    s_waitcnt vmcnt(11)
    buffer_load_dwordx4 v[76:79], v3, s[40:43], s61 offen offset:256 nt
    v_mov_b32_dpp v52, v32 quad_perm:[0,0,0,0] row_mask:0xf bank_mask:0xf
    v_mov_b32_dpp v53, v34 quad_perm:[2,2,2,2] row_mask:0xf bank_mask:0xf
    s_nop 0
    v_add_f32_dpp v52, v33, v52 quad_perm:[1,1,1,1] row_mask:0xf bank_mask:0xf
    v_add_f32_dpp v53, v35, v53 quad_perm:[3,3,3,3] row_mask:0xf bank_mask:0xf
    v_add_f32 v19, v52, v53
    v_cvt_pk_bf16_f32 v52, v12, v13
    v_cvt_pk_bf16_f32 v53, v14, v15
    v_cvt_pk_bf16_f32 v54, v16, v17
    v_cvt_pk_bf16_f32 v55, v18, v19
    v_lshlrev_b32 v12, 16, v52
    v_and_b32 v13, 0xffff0000, v52
    v_lshlrev_b32 v14, 16, v53
    v_and_b32 v15, 0xffff0000, v53
    v_lshlrev_b32 v16, 16, v54
    v_and_b32 v17, 0xffff0000, v54
    v_lshlrev_b32 v18, 16, v55
    v_and_b32 v19, 0xffff0000, v55
    v_max3_f32 v52, v12, v13, v14
    v_max3_f32 v54, v15, v16, v17
    v_max3_f32 v52, v52, v18, v19
    v_max_f32 v52, v52, v54
    s_nop 1
    v_max_f32_dpp v52, v52, v52 row_half_mirror row_mask:0xf bank_mask:0xf
    s_mov_b32 s72, 0x3db8aa3b
    v_mov_b32 v54, v52
    s_nop 1
    v_permlane16_swap_b32 v54, v52
    v_max_f32 v52, v52, v54
    v_mov_b32 v54, v52
    s_nop 1
    v_permlane32_swap_b32 v54, v52
    v_max_f32 v52, v52, v54
    v_sub_f32 v12, v12, v52
    v_sub_f32 v13, v13, v52
    v_sub_f32 v14, v14, v52
    v_sub_f32 v15, v15, v52
    v_sub_f32 v16, v16, v52
    v_sub_f32 v17, v17, v52
    v_sub_f32 v18, v18, v52
    v_sub_f32 v19, v19, v52
    v_mul_f32 v12, s72, v12
    v_mul_f32 v13, s72, v13
    v_mul_f32 v14, s72, v14
    v_mul_f32 v15, s72, v15
    v_mul_f32 v16, s72, v16
    v_mul_f32 v17, s72, v17
    v_mul_f32 v18, s72, v18
    v_mul_f32 v19, s72, v19
    v_exp_f32 v12, v12
    v_exp_f32 v13, v13
    v_exp_f32 v14, v14
    v_exp_f32 v15, v15
    v_exp_f32 v16, v16
    v_exp_f32 v17, v17
    v_exp_f32 v18, v18
    v_exp_f32 v19, v19
    v_add_f32 v53, v12, v13
    v_add_f32 v54, v14, v15
    v_add_f32 v55, v16, v17
    v_add_f32 v56, v18, v19
    v_add_f32 v53, v53, v54
    v_add_f32 v55, v55, v56
    v_add_f32 v53, v53, v55
    s_nop 1
    v_add_f32_dpp v53, v53, v53 row_half_mirror row_mask:0xf bank_mask:0xf
    v_mov_b32 v54, v53
    s_nop 1
    v_permlane16_swap_b32 v54, v53
    v_add_f32 v53, v53, v54
    v_mov_b32 v54, v53
    s_nop 1
    v_permlane32_swap_b32 v54, v53
    v_add_f32 v53, v53, v54
    v_bfe_u32 v7, v1, 3, 1
    v_lshlrev_b32 v7, 5, v7
    s_lshl_b32 s72, s28, 3
    v_add_u32 v7, s72, v7
    s_mov_b64 exec, 0x101
    ds_write_b64 v7, v[52:53] offset:6400
    v_mov_b32 v54, 5128
    v_mov_b32 v55, 1
    s_mov_b64 exec, 1
    s_waitcnt lgkmcnt(0)
    ds_add_u32 v54, v55
    s_mov_b64 exec, -1
    s_waitcnt vmcnt(9)
    buffer_load_dwordx4 v[80:83], v3, s[40:43], s62 offen offset:0 nt
    s_waitcnt vmcnt(9)
    buffer_load_dwordx4 v[84:87], v3, s[40:43], s62 offen offset:256 nt
    s_waitcnt vmcnt(9)
    buffer_load_dwordx4 v[88:91], v3, s[40:43], s63 offen offset:0 nt
    s_waitcnt vmcnt(9)
    buffer_load_dwordx4 v[92:95], v3, s[40:43], s63 offen offset:256 nt
    s_waitcnt vmcnt(9)
    buffer_load_dwordx4 v[96:99], v3, s[40:43], s64 offen offset:0 nt
    s_waitcnt vmcnt(9)
    buffer_load_dwordx4 v[100:103], v3, s[40:43], s64 offen offset:256 nt
    s_waitcnt vmcnt(9)
    buffer_load_dwordx4 v[104:107], v3, s[40:43], s65 offen offset:0 nt
    s_waitcnt vmcnt(9)
    buffer_load_dwordx4 v[108:111], v3, s[40:43], s65 offen offset:256 nt
    s_waitcnt vmcnt(9)
    buffer_load_dwordx4 v[112:115], v3, s[40:43], s66 offen offset:0 nt
    s_waitcnt vmcnt(9)
    buffer_load_dwordx4 v[116:119], v3, s[40:43], s66 offen offset:256 nt
    s_waitcnt vmcnt(9)
    buffer_load_dwordx4 v[120:123], v3, s[40:43], s67 offen offset:0 nt
    s_waitcnt vmcnt(9)
    buffer_load_dwordx4 v[124:127], v3, s[40:43], s67 offen offset:256 nt
    s_waitcnt vmcnt(9)
    buffer_load_dwordx4 v[144:147], v63, s[48:51], 0 offen nt
    buffer_load_dwordx4 v[128:131], v62, s[44:47], 0 offen offset:0 nt
    buffer_load_dwordx4 v[136:139], v62, s[44:47], 0 offen offset:896 nt
    s_mov_b32 exec_lo, 0x0fff0fff
    s_mov_b32 exec_hi, 0x0fff0fff
    buffer_load_dwordx4 v[148:151], v63, s[48:51], 0 offen offset:256 nt
    buffer_load_dwordx4 v[132:135], v62, s[44:47], 0 offen offset:256 nt
    buffer_load_dwordx4 v[140:143], v62, s[44:47], 0 offen offset:1152 nt
    s_mov_b64 exec, -1
    v_cvt_pk_bf16_f32 v12, v12, v12
    v_cvt_pk_bf16_f32 v13, v13, v13
    v_cvt_pk_bf16_f32 v14, v14, v14
    v_cvt_pk_bf16_f32 v15, v15, v15
    v_cvt_pk_bf16_f32 v16, v16, v16
    v_cvt_pk_bf16_f32 v17, v17, v17
    v_cvt_pk_bf16_f32 v18, v18, v18
    v_cvt_pk_bf16_f32 v19, v19, v19
    v_lshrrev_b32 v7, 1, v4
    v_lshlrev_b32 v7, 10, v7
    v_lshl_add_u32 v7, v6, 5, v7
    v_and_b32 v52, 1, v4
    v_lshl_add_u32 v7, v52, 4, v7
    s_lshl_b32 s72, s28, 11
    v_add_u32 v7, s72, v7
    v_lshlrev_b32 v52, 4, v52
    v_lshrrev_b32 v28, v52, s33
    v_lshrrev_b32 v29, 8, v28
    v_and_b32 v28, 0xff, v28
    v_and_b32 v29, 0xff, v29
    s_lshl_b32 s72, s29, 4
    s_lshr_b32 s73, s30, 1
    s_add_u32 s72, s72, s73
    s_lshl_b32 s72, s72, 12
    s_lshl_b32 s73, s28, 5
    s_add_u32 s72, s72, s73
    s_add_u32 s72, s72, 524288
    v_bfe_u32 v61, v1, 3, 1
    v_and_b32 v60, 7, v1
    v_lshl_add_u32 v52, v61, 4, v60
    v_lshl_add_u32 v60, v52, 7, s72
    v_lshl_add_u32 v60, v4, 3, v60
    v_lshl_add_u32 v3, v61, 4, v4
    s_lshl_b32 s72, s28, 4
    v_lshl_add_u32 v3, v3, 2, s72
    v_lshlrev_b32 v61, 2, v52
    v_and_b32 v2, 31, v1
    v_lshlrev_b32 v2, 2, v2
    s_lshl_b32 s72, s29, 5
    s_add_u32 s72, s72, s30
    s_lshl_b32 s72, s72, 7
    s_add_u32 s72, s72, 196608
    s_add_u32 s74, s26, s72
    s_addc_u32 s75, s27, 0
    s_mov_b32 s72, 0x01000100
    s_mov_b32 s73, 0x03020302
    s_mov_b32 s70, 0xffffff00
    v_mov_b32 v30, 5136
    s_lshr_b32 s35, s30, 1
    s_lshl_b32 s35, s35, 3
    s_add_u32 s35, s35, s29
    s_and_b32 s34, s30, 1
    s_lshl_b32 s34, s34, 2
    s_add_u32 s34, s34, s28
    s_lshl_b32 s34, s34, 7
    s_add_u32 s34, s34, s35
    s_lshl_b32 s34, s34, 2
    s_add_u32 s34, s34, 155648
    v_mov_b32 v31, s34
    v_mov_b32 v32, s33
    v_mov_b32_dpp v52, v12 row_half_mirror row_mask:0xf bank_mask:0xf
    v_and_b32 v36, v12, v8
    v_and_b32 v37, v12, v9
    v_and_b32 v42, v12, v10
    v_and_b32 v43, v12, v11
    v_and_b32 v38, v52, v10
    v_and_b32 v39, v52, v11
    v_and_b32 v40, v52, v8
    v_and_b32 v41, v52, v9
    v_mov_b32_dpp v52, v13 row_half_mirror row_mask:0xf bank_mask:0xf
    v_and_b32 v44, v13, v8
    v_and_b32 v45, v13, v9
    v_and_b32 v50, v13, v10
    v_and_b32 v51, v13, v11
    v_and_b32 v46, v52, v10
    v_and_b32 v47, v52, v11
    v_and_b32 v48, v52, v8
    v_and_b32 v49, v52, v9
    v_mfma_f32_16x16x32_bf16 v[20:23], v[36:39], v[192:195], 0
    v_mfma_f32_16x16x32_bf16 v[24:27], v[36:39], v[196:199], 0
    v_mfma_f32_16x16x32_bf16 v[20:23], v[40:43], v[200:203], v[20:23]
    v_mfma_f32_16x16x32_bf16 v[24:27], v[40:43], v[204:207], v[24:27]
    v_mov_b32_dpp v52, v14 row_half_mirror row_mask:0xf bank_mask:0xf
    v_and_b32 v36, v14, v8
    v_and_b32 v37, v14, v9
    v_and_b32 v42, v14, v10
    v_and_b32 v43, v14, v11
    v_and_b32 v38, v52, v10
    v_and_b32 v39, v52, v11
    v_and_b32 v40, v52, v8
    v_and_b32 v41, v52, v9
    v_mfma_f32_16x16x32_bf16 v[20:23], v[44:47], v[208:211], v[20:23]
    v_mfma_f32_16x16x32_bf16 v[24:27], v[44:47], v[212:215], v[24:27]
    v_mfma_f32_16x16x32_bf16 v[20:23], v[48:51], v[216:219], v[20:23]
    v_mfma_f32_16x16x32_bf16 v[24:27], v[48:51], v[220:223], v[24:27]
    v_mov_b32_dpp v52, v15 row_half_mirror row_mask:0xf bank_mask:0xf
    v_and_b32 v44, v15, v8
    v_and_b32 v45, v15, v9
    v_and_b32 v50, v15, v10
    v_and_b32 v51, v15, v11
    v_and_b32 v46, v52, v10
    v_and_b32 v47, v52, v11
    v_and_b32 v48, v52, v8
    v_and_b32 v49, v52, v9
    v_mfma_f32_16x16x32_bf16 v[20:23], v[36:39], v[224:227], v[20:23]
    v_mfma_f32_16x16x32_bf16 v[24:27], v[36:39], v[228:231], v[24:27]
    v_mfma_f32_16x16x32_bf16 v[20:23], v[40:43], v[232:235], v[20:23]
    v_mfma_f32_16x16x32_bf16 v[24:27], v[40:43], v[236:239], v[24:27]
    v_mov_b32_dpp v52, v16 row_half_mirror row_mask:0xf bank_mask:0xf
    v_and_b32 v36, v16, v8
    v_and_b32 v37, v16, v9
    v_and_b32 v42, v16, v10
    v_and_b32 v43, v16, v11
    v_and_b32 v38, v52, v10
    v_and_b32 v39, v52, v11
    v_and_b32 v40, v52, v8
    v_and_b32 v41, v52, v9
    v_mfma_f32_16x16x32_bf16 v[20:23], v[44:47], v[240:243], v[20:23]
    v_mfma_f32_16x16x32_bf16 v[24:27], v[44:47], v[244:247], v[24:27]
    v_mfma_f32_16x16x32_bf16 v[20:23], v[48:51], v[248:251], v[20:23]
    v_mfma_f32_16x16x32_bf16 v[24:27], v[48:51], v[252:255], v[24:27]
    v_mov_b32_dpp v52, v17 row_half_mirror row_mask:0xf bank_mask:0xf
    v_and_b32 v44, v17, v8
    v_and_b32 v45, v17, v9
    v_and_b32 v50, v17, v10
    v_and_b32 v51, v17, v11
    v_and_b32 v46, v52, v10
    v_and_b32 v47, v52, v11
    v_and_b32 v48, v52, v8
    v_and_b32 v49, v52, v9
    v_mfma_f32_16x16x32_bf16 v[20:23], v[36:39], v[64:67], v[20:23]
    v_mfma_f32_16x16x32_bf16 v[24:27], v[36:39], v[68:71], v[24:27]
    v_mfma_f32_16x16x32_bf16 v[20:23], v[40:43], v[72:75], v[20:23]
    v_mfma_f32_16x16x32_bf16 v[24:27], v[40:43], v[76:79], v[24:27]
    v_mov_b32_dpp v52, v18 row_half_mirror row_mask:0xf bank_mask:0xf
    v_and_b32 v36, v18, v8
    v_and_b32 v37, v18, v9
    v_and_b32 v42, v18, v10
    v_and_b32 v43, v18, v11
    v_and_b32 v38, v52, v10
    v_and_b32 v39, v52, v11
    v_and_b32 v40, v52, v8
    v_and_b32 v41, v52, v9
    s_waitcnt vmcnt(14)
    v_mfma_f32_16x16x32_bf16 v[20:23], v[44:47], v[80:83], v[20:23]
    v_mfma_f32_16x16x32_bf16 v[24:27], v[44:47], v[84:87], v[24:27]
    v_mfma_f32_16x16x32_bf16 v[20:23], v[48:51], v[88:91], v[20:23]
    v_mfma_f32_16x16x32_bf16 v[24:27], v[48:51], v[92:95], v[24:27]
    v_mov_b32_dpp v52, v19 row_half_mirror row_mask:0xf bank_mask:0xf
    v_and_b32 v44, v19, v8
    v_and_b32 v45, v19, v9
    v_and_b32 v50, v19, v10
    v_and_b32 v51, v19, v11
    v_and_b32 v46, v52, v10
    v_and_b32 v47, v52, v11
    v_and_b32 v48, v52, v8
    v_and_b32 v49, v52, v9
    s_waitcnt vmcnt(10)
    v_mfma_f32_16x16x32_bf16 v[20:23], v[36:39], v[96:99], v[20:23]
    v_mfma_f32_16x16x32_bf16 v[24:27], v[36:39], v[100:103], v[24:27]
    v_mfma_f32_16x16x32_bf16 v[20:23], v[40:43], v[104:107], v[20:23]
    v_mfma_f32_16x16x32_bf16 v[24:27], v[40:43], v[108:111], v[24:27]
    s_waitcnt vmcnt(9)
    v_mfma_f32_16x16x32_bf16 v[20:23], v[44:47], v[112:115], v[20:23]
    s_waitcnt vmcnt(8)
    v_mfma_f32_16x16x32_bf16 v[24:27], v[44:47], v[116:119], v[24:27]
    s_waitcnt vmcnt(7)
    v_mfma_f32_16x16x32_bf16 v[20:23], v[48:51], v[120:123], v[20:23]
    s_waitcnt vmcnt(6)
    v_mfma_f32_16x16x32_bf16 v[24:27], v[48:51], v[124:127], v[24:27]
    s_nop 5
    ds_write_b128 v7, v[20:23] offset:8192
    s_nop 0
    ds_write_b128 v7, v[24:27] offset:8704
    s_waitcnt lgkmcnt(0)
    s_barrier
    ds_read_b32 v52, v3 offset:6656
    s_waitcnt lgkmcnt(0)
    v_and_b32 v36, v52, v8
    v_and_b32 v37, v52, v9
    v_and_b32 v38, v52, v10
    v_and_b32 v39, v52, v11
    s_waitcnt vmcnt(2)
    s_nop 0
    v_mfma_f32_16x16x32_bf16 v[152:155], v[36:39], v[144:147], 0
    v_mfma_f32_16x16x32_bf16 v[156:159], v[36:39], v[148:151], 0
    s_cmp_eq_u32 s97, 2
    s_cbranch_scc0 L_o_spread
L_o_loc:
    s_mov_b32 s96, 0
    s_branch L_vp_o
L_vpr_o:
    s_cmp_ge_u32 s76, 48
    s_cbranch_scc1 L_vps_o
    s_sleep 2
L_vps_o:
    s_add_u32 s96, s96, 1
    s_cmp_ge_u32 s96, 2097152
    s_cbranch_scc1 L_end
L_vp_o:
    global_load_dword v64, v2, s[74:75] sc1
    s_waitcnt vmcnt(0)
    v_cmp_eq_u32 vcc, s33, v64
    s_nop 0
    s_bcnt1_i32_b64 s76, vcc
    s_cmp_ge_u32 s76, 48
    s_cbranch_scc0 L_vpr_o
    global_load_dwordx2 v[64:65], v60, s[26:27]
    global_load_dwordx2 v[66:67], v60, s[26:27] offset:1024
    s_branch L_o_go
L_o_spread:
    s_mov_b32 s96, 0
    s_branch L_sp_o
L_spr_o:
    s_cmp_ge_u32 s76, 12
    s_cbranch_scc1 L_sps_o
    s_sleep 2
L_sps_o:
    s_add_u32 s96, s96, 1
    s_cmp_lt_u32 s96, 1048576
    s_cbranch_scc1 L_sp_o
    s_endpgm
L_sp_o:
    s_load_dwordx16 s[36:51], s[74:75], 0 glc
    s_load_dwordx16 s[52:67], s[74:75], 64 glc
    s_mov_b32 s76, 0
    s_waitcnt lgkmcnt(0)
    s_cmp_eq_u64 s[36:37], s[98:99]
    s_addc_u32 s76, s76, 0
    s_cmp_eq_u64 s[38:39], s[98:99]
    s_addc_u32 s76, s76, 0
    s_cmp_eq_u64 s[40:41], s[98:99]
    s_addc_u32 s76, s76, 0
    s_cmp_eq_u64 s[42:43], s[98:99]
    s_addc_u32 s76, s76, 0
    s_cmp_eq_u64 s[44:45], s[98:99]
    s_addc_u32 s76, s76, 0
    s_cmp_eq_u64 s[46:47], s[98:99]
    s_addc_u32 s76, s76, 0
    s_cmp_eq_u64 s[48:49], s[98:99]
    s_addc_u32 s76, s76, 0
    s_cmp_eq_u64 s[50:51], s[98:99]
    s_addc_u32 s76, s76, 0
    s_cmp_eq_u64 s[52:53], s[98:99]
    s_addc_u32 s76, s76, 0
    s_cmp_eq_u64 s[54:55], s[98:99]
    s_addc_u32 s76, s76, 0
    s_cmp_eq_u64 s[56:57], s[98:99]
    s_addc_u32 s76, s76, 0
    s_cmp_eq_u64 s[58:59], s[98:99]
    s_addc_u32 s76, s76, 0
    s_cmp_eq_u64 s[60:61], s[98:99]
    s_addc_u32 s76, s76, 0
    s_cmp_eq_u64 s[62:63], s[98:99]
    s_addc_u32 s76, s76, 0
    s_cmp_eq_u64 s[64:65], s[98:99]
    s_addc_u32 s76, s76, 0
    s_cmp_eq_u64 s[66:67], s[98:99]
    s_addc_u32 s76, s76, 0
    s_cmp_ge_u32 s76, 12
    s_cbranch_scc0 L_spr_o
    global_load_dwordx2 v[64:65], v60, s[26:27] sc1
    global_load_dwordx2 v[66:67], v60, s[26:27] offset:1024 sc1
L_o_go:
    s_mov_b32 s96, 0
L_wp:
    ds_read_b32 v52, v30
    ds_read_b32 v53, v61 offset:6528
    ds_read_b32 v54, v61 offset:6560
    s_add_u32 s96, s96, 1
    s_cmp_ge_u32 s96, 4194304
    s_cbranch_scc1 L_end
    s_waitcnt lgkmcnt(0)
    v_readfirstlane_b32 s76, v52
    s_nop 0
    s_cmp_eq_u32 s76, 1
    s_cbranch_scc0 L_wp
    s_mov_b32 s96, 0
    s_mov_b64 s[78:79], exec
    s_waitcnt vmcnt(0)
    s_branch L_chk_o
L_poll_o:
    global_load_dwordx2 v[64:65], v60, s[26:27] sc1
    global_load_dwordx2 v[66:67], v60, s[26:27] offset:1024 sc1
    s_waitcnt vmcnt(0)
L_chk_o:
    v_xor_b32 v68, v64, v28
    v_xor_b32 v69, v65, v29
    v_xor_b32 v70, v66, v28
    v_or3_b32 v68, v68, v69, v70
    v_xor_b32 v69, v67, v29
    v_or_b32 v68, v68, v69
    v_and_b32 v68, 0xff, v68
    v_cmp_ne_u32 vcc, 0, v68
    s_nop 0
    s_cmp_lg_u64 vcc, 0
    s_cbranch_scc0 L_got_o
    s_bcnt1_i32_b64 s76, vcc
    s_cmp_gt_u32 s76, 16
    s_cbranch_scc0 L_short_o
    s_sleep 4
L_short_o:
    s_add_u32 s96, s96, 1
    s_cmp_lt_u32 s96, 524288
    s_cbranch_scc1 L_poll_o
    s_endpgm
L_got_o:
    s_mov_b64 exec, s[78:79]
L_o_have:
    s_mov_b64 exec, 1
    global_store_dword v31, v32, s[26:27] sc1
    s_mov_b64 exec, -1
    v_and_b32 v64, s70, v64
    v_and_b32 v65, s70, v65
    v_and_b32 v66, s70, v66
    v_and_b32 v67, s70, v67
    v_mul_f32 v64, v64, v53
    v_mul_f32 v65, v65, v53
    v_fma_f32 v64, v66, v54, v64
    v_fma_f32 v65, v67, v54, v65
    s_nop 0
    v_add_f32_dpp v64, v64, v64 quad_perm:[1,0,3,2] row_mask:0xf bank_mask:0xf
    v_add_f32_dpp v65, v65, v65 quad_perm:[1,0,3,2] row_mask:0xf bank_mask:0xf
    s_nop 0
    v_add_f32_dpp v64, v64, v64 quad_perm:[2,3,0,1] row_mask:0xf bank_mask:0xf
    v_add_f32_dpp v65, v65, v65 quad_perm:[2,3,0,1] row_mask:0xf bank_mask:0xf
    s_nop 0
    v_add_f32_dpp v64, v64, v64 row_half_mirror row_mask:0xf bank_mask:0xf
    v_add_f32_dpp v65, v65, v65 row_half_mirror row_mask:0xf bank_mask:0xf
    v_cvt_pk_bf16_f32 v66, v64, v65
    v_perm_b32 v67, v66, v66, s72
    v_perm_b32 v68, v66, v66, s73
    v_and_b32 v36, v67, v8
    v_and_b32 v37, v67, v9
    v_and_b32 v38, v67, v10
    v_and_b32 v39, v67, v11
    v_and_b32 v40, v68, v8
    v_and_b32 v41, v68, v9
    v_and_b32 v42, v68, v10
    v_and_b32 v43, v68, v11
    v_mfma_f32_16x16x32_bf16 v[152:155], v[36:39], v[128:131], v[152:155]
    v_mfma_f32_16x16x32_bf16 v[156:159], v[36:39], v[132:135], v[156:159]
    v_mfma_f32_16x16x32_bf16 v[152:155], v[40:43], v[136:139], v[152:155]
    v_mfma_f32_16x16x32_bf16 v[156:159], v[40:43], v[140:143], v[156:159]
    s_lshl_b32 s72, s32, 3
    s_add_u32 s72, s72, s29
    s_cmp_ge_u32 s72, 14
    s_cselect_b32 s73, 1, 0
    s_mul_i32 s74, s73, 14
    s_sub_u32 s34, s72, s74
    s_nop 0
    ds_write_b128 v7, v[152:155] offset:16384
    ds_write_b128 v7, v[156:159] offset:16896
    s_lshl_b32 s75, s31, 1
    s_add_u32 s75, s75, s73
    s_mul_i32 s75, s75, 114688
    s_lshl_b32 s74, s34, 6
    s_add_u32 s74, s74, s75
    s_add_u32 s74, s74, 1048576
    s_waitcnt lgkmcnt(0)
    s_barrier
    s_cmp_lt_u32 s72, 28
    s_cbranch_scc0 L_s_fin
    s_add_u32 s68, s26, s74
    s_addc_u32 s69, s27, 0
    s_mov_b32 s70, 114688
    s_mov_b32 s71, 0x20000
    s_mul_i32 s35, s28, 28672
    s_add_u32 s97, s35, 14336
    s_cmp_ge_u32 s34, 7
    s_cselect_b32 s34, 1, 0
    s_lshl_b32 s73, s73, 1
    s_add_u32 s73, s73, s31
    s_lshl_b32 s73, s73, 1
    s_add_u32 s73, s73, s34
    s_lshl_b32 s73, s73, 2
    s_add_u32 s73, s73, s28
    s_lshl_b32 s73, s73, 7
    s_add_u32 s73, s73, 155648
    s_add_u32 s74, s26, s73
    s_addc_u32 s75, s27, 0
    v_lshrrev_b32 v2, 2, v1
    v_mul_u32_u24 v2, 896, v2
    v_lshl_add_u32 v2, v5, 4, v2
    s_mul_i32 s73, s31, 896
    s_lshl_b32 s72, s72, 5
    s_add_u32 s72, s72, s73
    v_and_b32 v8, 7, v1
    v_lshl_add_u32 v3, v8, 2, s72
    global_load_dword v6, v3, s[4:5]
    v_lshrrev_b32 v9, 5, v1
    v_lshlrev_b32 v9, 1, v9
    v_bfe_u32 v10, v1, 4, 1
    v_add_u32 v9, v9, v10
    v_lshl_add_u32 v9, v5, 2, v9
    s_lshl_b32 s72, s28, 6
    v_lshl_add_u32 v7, v9, 2, s72
    v_lshlrev_b32 v8, 3, v8
    v_add_u32 v8, 6784, v8
    s_and_b32 s72, s33, 0xff
    v_mov_b32 v12, s72
    s_bfe_u32 s72, s33, 0x80008
    v_mov_b32 v13, s72
    s_bfe_u32 s72, s33, 0x80010
    v_mov_b32 v14, s72
    s_lshr_b32 s72, s33, 24
    v_mov_b32 v15, s72
    s_mov_b32 s73, 0xffffff00
    s_mov_b32 s96, 0
    s_branch L_sp_a
L_spr_a:
    s_cmp_ge_u32 s76, 12
    s_cbranch_scc1 L_sps_a
    s_sleep 2
L_sps_a:
    s_add_u32 s96, s96, 1
    s_cmp_lt_u32 s96, 1048576
    s_cbranch_scc1 L_sp_a
    s_endpgm
L_sp_a:
    s_load_dwordx16 s[36:51], s[74:75], 0 glc
    s_load_dwordx16 s[52:67], s[74:75], 64 glc
    s_mov_b32 s76, 0
    s_waitcnt lgkmcnt(0)
    s_cmp_eq_u64 s[36:37], s[98:99]
    s_addc_u32 s76, s76, 0
    s_cmp_eq_u64 s[38:39], s[98:99]
    s_addc_u32 s76, s76, 0
    s_cmp_eq_u64 s[40:41], s[98:99]
    s_addc_u32 s76, s76, 0
    s_cmp_eq_u64 s[42:43], s[98:99]
    s_addc_u32 s76, s76, 0
    s_cmp_eq_u64 s[44:45], s[98:99]
    s_addc_u32 s76, s76, 0
    s_cmp_eq_u64 s[46:47], s[98:99]
    s_addc_u32 s76, s76, 0
    s_cmp_eq_u64 s[48:49], s[98:99]
    s_addc_u32 s76, s76, 0
    s_cmp_eq_u64 s[50:51], s[98:99]
    s_addc_u32 s76, s76, 0
    s_cmp_eq_u64 s[52:53], s[98:99]
    s_addc_u32 s76, s76, 0
    s_cmp_eq_u64 s[54:55], s[98:99]
    s_addc_u32 s76, s76, 0
    s_cmp_eq_u64 s[56:57], s[98:99]
    s_addc_u32 s76, s76, 0
    s_cmp_eq_u64 s[58:59], s[98:99]
    s_addc_u32 s76, s76, 0
    s_cmp_eq_u64 s[60:61], s[98:99]
    s_addc_u32 s76, s76, 0
    s_cmp_eq_u64 s[62:63], s[98:99]
    s_addc_u32 s76, s76, 0
    s_cmp_eq_u64 s[64:65], s[98:99]
    s_addc_u32 s76, s76, 0
    s_cmp_eq_u64 s[66:67], s[98:99]
    s_addc_u32 s76, s76, 0
    s_cmp_ge_u32 s76, 16
    s_cbranch_scc0 L_spr_a
    s_mov_b32 s96, 0
    s_mov_b64 s[78:79], exec
L_poll_a:
    buffer_load_dwordx4 v[64:67], v2, s[68:71], s35 offen sc1
    buffer_load_dwordx4 v[68:71], v2, s[68:71], s97 offen sc1
    s_waitcnt vmcnt(0)
L_chk_a:
    v_xor_b32 v72, v64, v12
    v_xor_b32 v73, v65, v13
    v_xor_b32 v74, v66, v14
    v_or3_b32 v72, v72, v73, v74
    v_xor_b32 v73, v67, v15
    v_xor_b32 v74, v68, v12
    v_or3_b32 v72, v72, v73, v74
    v_xor_b32 v73, v69, v13
    v_xor_b32 v74, v70, v14
    v_or3_b32 v72, v72, v73, v74
    v_xor_b32 v73, v71, v15
    v_or_b32 v72, v72, v73
    v_and_b32 v72, 0xff, v72
    v_cmp_ne_u32 vcc, 0, v72
    s_nop 0
    s_cmp_lg_u64 vcc, 0
    s_cbranch_scc0 L_got_a
    s_bcnt1_i32_b64 s76, vcc
    s_cmp_gt_u32 s76, 16
    s_cbranch_scc0 L_short_a
    s_sleep 4
L_short_a:
    s_add_u32 s96, s96, 1
    s_cmp_lt_u32 s96, 524288
    s_cbranch_scc1 L_poll_a
    s_endpgm
L_got_a:
    s_mov_b64 exec, s[78:79]
    v_and_b32 v64, s73, v64
    v_and_b32 v65, s73, v65
    v_and_b32 v66, s73, v66
    v_and_b32 v67, s73, v67
    v_and_b32 v68, s73, v68
    v_and_b32 v69, s73, v69
    v_and_b32 v70, s73, v70
    v_and_b32 v71, s73, v71
    v_pk_add_f32 v[64:65], v[64:65], v[68:69]
    v_pk_add_f32 v[66:67], v[66:67], v[70:71]
    s_nop 1
    v_permlane32_swap_b32 v64, v66
    v_permlane32_swap_b32 v65, v67
    v_add_f32 v64, v64, v66
    v_add_f32 v65, v65, v67
    s_nop 1
    v_permlane16_swap_b32 v64, v65
    v_add_f32 v64, v64, v65
    s_nop 1
    v_add_f32_dpp v64, v64, v64 row_ror:4 row_mask:0xf bank_mask:0xf
    s_nop 1
    v_add_f32_dpp v64, v64, v64 row_ror:8 row_mask:0xf bank_mask:0xf
    s_mov_b32 exec_lo, 0x000f000f
    s_mov_b32 exec_hi, 0x000f000f
    ds_write_b32 v7, v64 offset:6784
    s_mov_b64 exec, 0xff
    v_lshlrev_b32 v68, 16, v6
    v_and_b32 v69, 0xffff0000, v6
    s_waitcnt lgkmcnt(0)
    s_barrier
    s_cmp_eq_u32 s28, 0
    s_cbranch_scc0 L_s_fin
    ds_read2_b64 v[72:75], v8 offset0:0 offset1:8
    ds_read2_b64 v[76:79], v8 offset0:16 offset1:24
    s_waitcnt lgkmcnt(0)
    v_pk_add_f32 v[72:73], v[72:73], v[74:75]
    v_pk_add_f32 v[76:77], v[76:77], v[78:79]
    v_pk_add_f32 v[72:73], v[72:73], v[76:77]
    v_pk_add_f32 v[72:73], v[72:73], v[68:69]
    v_cvt_pk_bf16_f32 v64, v72, v73
    global_store_dword v3, v64, s[22:23]
L_s_fin:
    s_add_u32 s28, s28, 4
L_fin:
L_end:
    s_endpgm
.section .rodata,"a"
.p2align 6
.amdhsa_kernel parallel_sum__sliding_block_cached__geglu_ffn__decode_kernel
  .amdhsa_next_free_vgpr 256
  .amdhsa_next_free_sgpr 102
  .amdhsa_accum_offset 256
  .amdhsa_group_segment_fixed_size 0
  .amdhsa_kernarg_size 96
  .amdhsa_user_sgpr_count 2
  .amdhsa_user_sgpr_kernarg_segment_ptr 1
  .amdhsa_system_sgpr_workgroup_id_x 1
  .amdhsa_float_denorm_mode_32 3
.end_amdhsa_kernel
```
